```python
import torch

def _softmax(x, axis=-1):
    return torch.softmax(x, dim=axis)

def _gelu(x):
    return torch.nn.functional.gelu(x, approximate='tanh')

def _silu(x):
    return torch.nn.functional.silu(x)

def _sigmoid(x):
    return torch.sigmoid(x)

def _layernorm(x, axis=-1, eps=1e-05):
    m = x.mean(dim=axis, keepdim=True)
    v = x.var(dim=axis, keepdim=True, unbiased=False)
    return (x - m) / torch.sqrt(v + eps)

def _scatter_add(tgt, idx, src, axis=0):
    return tgt.clone().index_add_(axis, idx, src)

def _segment_sum(src, seg, n):
    out = torch.zeros((n,) + src.shape[1:], dtype=src.dtype)
    return out.index_add_(0, seg, src)

def _pad(x, pw):
    flat = tuple((v for pair in reversed(pw) for v in pair))
    return torch.nn.functional.pad(x, flat)
kernel_name = 'standalone__dilated_atrous__vision'

def setup_inputs():

    _w = lambda a: (lambda t: t.to(torch.bfloat16) if t.is_floating_point() else t)(torch.as_tensor(a))
    H = W = 224
    C = 96
    k = 5
    return {'x': _w((lambda *s: torch.randn(*s, dtype=torch.bfloat16) * 0.05)(1, H, W, C)), 'w': _w((lambda *s: torch.randn(*s, dtype=torch.bfloat16) * 0.05)(k, k, C, C) * (1.0 / (k * C ** 0.5)))}

def reference(x, w):
    B, H, W, C = x.shape
    k = 5
    rate = 2
    pad = (k - 1) * rate // 2
    xp = _pad(x, ((0, 0), (pad, pad), (pad, pad), (0, 0)))
    out = torch.zeros_like(x)
    for i in range(k):
        for j in range(k):
            tap = xp[:, i * rate:i * rate + H, j * rate:j * rate + W, :].clone()
            out = out + torch.einsum('bhwc,co->bhwo', tap, w[i, j])
    return out
```

```asm
; @launch grid=(256,1,1) block=(512,1,1) lds=161792
.amdgcn_target "amdgcn-amd-amdhsa--gfx950"
.text
.globl standalone__dilated_atrous__vision_kernel
.p2align 12
.p2align 8
.type standalone__dilated_atrous__vision_kernel,@function
standalone__dilated_atrous__vision_kernel:
    s_load_dwordx2 s[16:17], s[0:1], 0
    s_load_dwordx2 s[20:21], s[0:1], 8
    s_load_dwordx2 s[24:25], s[0:1], 16
    s_cmp_ge_u32 s2, 256
    s_cbranch_scc1 L_exit
    s_and_b32 s28, s2, 1
    s_bfe_u32 s3, s2, 0x20001
    s_lshl_b32 s3, s3, 5
    s_lshr_b32 s33, s2, 3
    s_add_u32 s3, s3, s33
    s_cmp_ge_u32 s3, 126
    s_cbranch_scc1 L_exit
    v_lshrrev_b32 v2, 6, v0
    v_and_b32 v1, 63, v0
    v_readfirstlane_b32 s32, v2
    v_lshlrev_b32 v30, 2, v0
    v_add_u32 v30, 159744, v30
    v_mov_b32 v31, 0
    ds_write_b32 v30, v31
    s_mul_i32 s33, s3, 4682
    s_lshr_b32 s33, s33, 16
    s_mul_i32 s34, s33, 14
    s_sub_u32 s34, s3, s34
    s_and_b32 s29, s34, 1
    s_lshr_b32 s30, s34, 1
    s_lshl_b32 s30, s30, 4
    s_mul_i32 s31, s33, 25
    s_lshr_b32 s31, s31, 1
    s_and_b32 s34, s33, 1
    s_lshl_b32 s35, s31, 1
    s_add_u32 s35, s35, s28
    s_mul_i32 s35, s35, 43008
    s_lshl_b32 s36, s30, 1
    s_add_u32 s36, s36, s29
    s_mul_i32 s36, s36, 192
    s_lshl_b32 s52, s29, 1
    s_sub_u32 s52, 2, s52
    s_cmp_ge_u32 s32, 4
    s_cbranch_scc0 L_ld
    s_bfe_u32 s31, s32, 0x10001
    s_lshl1_add_u32 s31, s34, s31
    s_cmp_eq_u32 s33, 8
    s_cselect_b32 s31, 3, s31
    s_getpc_b64 s[38:39]
L_pc:
    s_lshr_b32 s37, s2, 1
    s_and_b32 s37, s37, 0x7c
    s_add_u32 s37, s37, s32
    s_min_u32 s37, s37, (L_end-L_pc)/256
    s_lshl_b32 s37, s37, 8
    s_add_u32 s38, s38, s37
    s_addc_u32 s39, s39, 0
    v_mov_b32 v12, s38
    v_mov_b32 v13, s39
    global_load_dword v14, v[12:13], off
    global_load_dword v15, v[12:13], off offset:128
    s_bitcmp1_b32 s32, 0
    s_cbranch_scc0 L_compute
    s_cmp_eq_u32 s31, 0
    s_cbranch_scc1 L_pad0
    s_cmp_eq_u32 s31, 1
    s_cbranch_scc1 L_pad1
    s_cmp_eq_u32 s31, 2
    s_cbranch_scc1 L_pad2
    s_branch L_pad3
L_ld:
    s_add_u32 s37, s35, s36
    s_sub_u32 s37, s37, 172800
    s_sub_u32 s38, s30, 2
    s_cmp_eq_u32 s29, 0
    s_cselect_b32 s14, 32, -32
    s_cselect_b32 s15, 0, 320
    s_mul_i32 s10, s14, 21504
    s_and_b32 s11, s32, 1
    s_lshl_b32 s39, s11, 4
    s_add_u32 s15, s15, s39
    v_lshrrev_b32 v13, 2, v1
    v_add_u32 v13, s15, v13
    v_lshrrev_b32 v14, 3, v1
    v_and_b32 v14, 2, v14
    v_and_b32 v15, 3, v1
    v_xor_b32 v14, v14, v15
    v_lshlrev_b32 v14, 4, v14
    v_add_u32 v14, s37, v14
    v_bfrev_b32 v19, 1
    s_movk_i32 s39, 3277
    s_mov_b32 s49, 86016
    s_movk_i32 s50, 384
    s_movk_i32 s51, 112
    v_mul_u32_u24 v15, s39, v13
    v_lshrrev_b32 v15, 16, v15
    v_mul_u32_u24 v16, 20, v15
    v_sub_u32 v16, v13, v16
    v_add_u32 v17, s38, v16
    v_cmp_gt_u32 vcc, s51, v17
    v_mad_u32_u24 v18, v15, s49, v14
    v_mad_u32_u24 v18, v16, s50, v18
    v_cndmask_b32 v2, v19, v18, vcc
    v_add_u32 v13, s14, v13
    v_add_u32 v7, s10, v2
    v_mul_u32_u24 v15, s39, v13
    v_lshrrev_b32 v15, 16, v15
    v_mul_u32_u24 v16, 20, v15
    v_sub_u32 v16, v13, v16
    v_add_u32 v17, s38, v16
    v_cmp_gt_u32 vcc, s51, v17
    v_mad_u32_u24 v18, v15, s49, v14
    v_mad_u32_u24 v18, v16, s50, v18
    v_cndmask_b32 v3, v19, v18, vcc
    v_add_u32 v13, s14, v13
    v_add_u32 v8, s10, v3
    v_mul_u32_u24 v15, s39, v13
    v_lshrrev_b32 v15, 16, v15
    v_mul_u32_u24 v16, 20, v15
    v_sub_u32 v16, v13, v16
    v_add_u32 v17, s38, v16
    v_cmp_gt_u32 vcc, s51, v17
    v_mad_u32_u24 v18, v15, s49, v14
    v_mad_u32_u24 v18, v16, s50, v18
    v_cndmask_b32 v4, v19, v18, vcc
    v_add_u32 v13, s14, v13
    v_add_u32 v9, s10, v4
    v_mul_u32_u24 v15, s39, v13
    v_lshrrev_b32 v15, 16, v15
    v_mul_u32_u24 v16, 20, v15
    v_sub_u32 v16, v13, v16
    v_add_u32 v17, s38, v16
    v_cmp_gt_u32 vcc, s51, v17
    v_mad_u32_u24 v18, v15, s49, v14
    v_mad_u32_u24 v18, v16, s50, v18
    v_cndmask_b32 v5, v19, v18, vcc
    v_add_u32 v13, s14, v13
    v_add_u32 v10, s10, v5
    v_mul_u32_u24 v15, s39, v13
    v_lshrrev_b32 v15, 16, v15
    v_mul_u32_u24 v16, 20, v15
    v_sub_u32 v16, v13, v16
    v_add_u32 v17, s38, v16
    v_cmp_gt_u32 vcc, s51, v17
    v_mad_u32_u24 v18, v15, s49, v14
    v_mad_u32_u24 v18, v16, s50, v18
    v_cndmask_b32 v6, v19, v18, vcc
    v_add_u32 v11, s10, v6
    v_add_u32 v12, s10, v7
    s_lshl_b32 s57, s52, 6
    s_lshl_b32 s56, s15, 6
    s_lshl_b32 s14, s14, 6
    v_lshlrev_b32 v20, 4, v1
    v_cmp_gt_u32 vcc, 32, v1
    v_xor_b32 v22, 32, v20
    s_lshr_b32 s39, s2, 2
    v_cndmask_b32 v21, v22, v20, vcc
    s_and_b32 s39, s39, 28
    s_lshr_b32 s39, 0x21043210, s39
    s_and_b32 s39, s39, 7
    s_mul_i32 s38, s11, 5
    s_add_u32 s39, s39, s38
    s_mul_i32 s40, s39, 3072
    s_lshr_b32 s41, s39, 1
    s_mul_i32 s41, s41, 86016
    s_add_u32 s41, s41, s40
    s_movk_i32 s42, 3072
    s_bitcmp1_b32 s39, 0
    s_cselect_b32 s42, 89088, s42
    s_mov_b32 s43, 4
    s_cmp_ge_u32 s32, 2
    s_cselect_b32 s95, 1, 0
    s_cselect_b32 s44, -1, 4
    s_mul_i32 s54, s95, 30720
    s_add_u32 s54, s54, 67584
    s_mul_i32 s37, s95, 3
    s_add_u32 s37, s37, s52
    s_mul_i32 s37, s37, 6144
    s_mov_b32 s55, 0
    s_mov_b32 s15, 15
    s_mov_b32 s18, 9633792
    s_mov_b32 s19, 0x20000
    s_mov_b32 s22, 460800
    s_mov_b32 s23, s19
    s_waitcnt lgkmcnt(0)
    s_cmp_eq_u32 s95, 1
    s_cbranch_scc0 L_w_early
L_x_loop:
    s_bitcmp1_b32 s15, 0
    s_cbranch_scc0 L_x0
    s_mov_b32 m0, s56
    s_add_u32 s56, s56, s14
    buffer_load_dwordx4 v2, s[16:19], s57 offen lds
    s_mov_b32 m0, s56
    s_add_u32 s56, s56, s14
    buffer_load_dwordx4 v3, s[16:19], s57 offen lds
    s_mov_b32 m0, s56
    s_add_u32 s56, s56, s14
    buffer_load_dwordx4 v4, s[16:19], s57 offen lds
L_x0:
    s_bitcmp1_b32 s15, 1
    s_cbranch_scc0 L_x1
    s_mov_b32 m0, s56
    s_add_u32 s56, s56, s14
    buffer_load_dwordx4 v5, s[16:19], s57 offen lds
    s_mov_b32 m0, s56
    s_add_u32 s56, s56, s14
    buffer_load_dwordx4 v6, s[16:19], s57 offen lds
    s_mov_b32 m0, s56
    s_add_u32 s56, s56, s14
    buffer_load_dwordx4 v7, s[16:19], s57 offen lds
L_x1:
    s_bitcmp1_b32 s15, 2
    s_cbranch_scc0 L_x2
    s_mov_b32 m0, s56
    s_add_u32 s56, s56, s14
    buffer_load_dwordx4 v8, s[16:19], s57 offen lds
    s_mov_b32 m0, s56
    s_add_u32 s56, s56, s14
    buffer_load_dwordx4 v9, s[16:19], s57 offen lds
    s_mov_b32 m0, s56
    s_add_u32 s56, s56, s14
    buffer_load_dwordx4 v10, s[16:19], s57 offen lds
L_x2:
    s_bitcmp1_b32 s15, 3
    s_cbranch_scc0 L_x_next
    s_mov_b32 m0, s56
    s_add_u32 s56, s56, s14
    buffer_load_dwordx4 v11, s[16:19], s57 offen lds
    s_mov_b32 m0, s56
    s_add_u32 s56, s56, s14
    buffer_load_dwordx4 v12, s[16:19], s57 offen lds
    s_cmp_lg_u32 s55, 0
    s_cbranch_scc1 L_x_sig
    s_barrier
    v_mov_b32 v26, 1
    s_waitcnt vmcnt(0)
    ds_write_b32 v30, v26
    s_branch L_w_it
L_w_early:
L_w_it:
    s_add_u32 m0, s54, s40
    s_add_u32 s50, s37, s41
    buffer_load_dwordx4 v20, s[20:23], s50 offen offset:0 lds
    buffer_load_dwordx4 v21, s[20:23], s50 offen offset:1024 lds
    buffer_load_dwordx4 v22, s[20:23], s50 offen offset:2048 lds
    s_cmp_lg_u32 s43, s44
    s_cbranch_scc1 L_w_step
    s_barrier
    s_mov_b32 s44, -1
L_w_step:
    s_addk_i32 s40, 3072
    s_add_u32 s41, s41, s42
    s_xor_b32 s42, s42, 86016
    s_cmpk_eq_u32 s40, 30720
    s_cselect_b32 s40, 0, s40
    s_cselect_b32 s41, 0, s41
    s_sub_u32 s43, s43, 1
    s_cbranch_scc0 L_w_it
    s_cmp_lg_u32 s55, 0
    s_cbranch_scc1 L_w_adv
    s_cmp_eq_u32 s95, 1
    s_cbranch_scc1 L_x_w1
    s_mov_b32 s55, s32
    s_mov_b32 s53, s32
    s_mul_i32 s50, s32, 30720
    s_add_u32 s54, s54, s50
    v_mov_b32 v31, s32
L_w_adv:
    v_add_u32 v31, 2, v31
    s_waitcnt vmcnt(0)
    ds_write_b32 v30, v31
    s_sub_u32 s54, s54, 30720
    s_cmp_lt_u32 s54, 67584
    s_cselect_b32 s50, 92160, 0
    s_add_u32 s54, s54, s50
    s_add_u32 s53, s53, 2
    s_cmp_ge_u32 s53, 5
    s_cselect_b32 s50, 5, 0
    s_sub_u32 s53, s53, s50
    s_lshr_b32 s50, s50, 2
    s_add_u32 s52, s52, s50
    s_cmp_eq_u32 s52, 3
    s_cselect_b32 s52, 0, s52
    s_mul_i32 s37, s53, 3
    s_add_u32 s37, s37, s52
    s_mul_i32 s37, s37, 6144
    s_mov_b32 s43, 9
    s_mov_b32 s51, s55
    s_add_u32 s55, s55, 2
    s_max_u32 s51, s51, 1
    s_cmp_ge_u32 s55, 15
    s_cbranch_scc1 L_store
    v_and_b32 v23, 3, v1
    v_mul_u32_u24 v23, 260, v23
    v_add_u32 v23, 160768, v23
L_w_poll:
    ds_read_b32 v24, v23
    s_waitcnt lgkmcnt(0)
    v_cmp_gt_u32 vcc, s51, v24
    s_cbranch_vccnz L_w_poll
    s_branch L_w_it
L_x_w1:
    s_mov_b32 s92, 0x68544231
    s_mov_b32 s93, 0x9c83
    s_mov_b32 s55, 1
L_x_sig:
    v_add_u32 v31, 5, v31
    s_waitcnt vmcnt(0)
    ds_write_b32 v30, v31
    s_mul_i32 s50, s14, -11
    s_add_u32 s56, s56, s50
    s_add_u32 s56, s56, 22528
    s_add_u32 s57, s57, 64
    s_cmp_eq_u32 s57, 192
    s_cselect_b32 s57, 0, s57
L_x_next:
    s_and_b32 s15, s92, 15
    s_cbranch_scc0 L_xdone
    s_bfe_u32 s51, s92, 0x40004
    s_lshr_b64 s[92:93], s[92:93], 8
    v_and_b32 v22, 1, v1
    v_mul_u32_u24 v22, 260, v22
    v_add_u32 v22, 159744, v22
L_x_poll:
    ds_read_b32 v23, v22
    s_waitcnt lgkmcnt(0)
    v_cmp_gt_u32 vcc, s51, v23
    s_cbranch_vccnz L_x_poll
    s_branch L_x_loop
L_xdone:
    s_lshl1_add_u32 s39, s34, s11
    s_cmp_eq_u32 s33, 8
    s_cselect_b32 s39, 3, s39
    s_cmp_eq_u32 s39, 0
    s_cbranch_scc1 L_padf0
    s_cmp_eq_u32 s39, 1
    s_cbranch_scc1 L_padf1
    s_cmp_eq_u32 s39, 2
    s_cbranch_scc1 L_padf2
    s_branch L_padf3
L_store:
L_store2:
    s_mov_b32 s26, 9633792
    s_mov_b32 s27, 0x20000
    s_movk_i32 s49, 208
    s_movk_i32 s50, 384
    v_lshrrev_b32 v11, 2, v1
    v_and_b32 v12, 3, v1
    v_lshlrev_b32 v12, 4, v12
    v_mad_u32_u24 v5, v11, s50, v12
    v_mad_u32_u24 v2, v11, s49, v12
    v_and_b32 v10, 1, v1
    v_mul_u32_u24 v10, 260, v10
    s_lshl_b32 s39, s95, 9
    s_add_u32 s39, s39, 160768
    v_add_u32 v10, s39, v10
    s_add_u32 s45, s35, s36
    s_or_b32 s38, s34, s95
    s_cmp_eq_u32 s33, 8
    s_cselect_b32 s38, 1, s38
    s_cselect_b32 s43, 6, 7
    s_xor_b32 s38, s38, 1
    s_andn2_b32 s44, s34, s95
    s_add_u32 s39, s34, 6
    s_mul_i32 s39, s39, s95
    s_add_u32 s39, s39, s44
    s_add_u32 s39, s39, 5
    s_cmp_eq_u32 s38, 1
    s_cselect_b32 s39, 0, s39
    s_cselect_b32 s42, 1, -1
    s_mul_i32 s40, s11, s42
    s_add_u32 s39, s39, s40
    s_mul_i32 s47, s39, 86016
    s_add_u32 s47, s47, s45
    s_mul_i32 s48, s39, 3328
    v_add_u32 v12, s48, v2
    s_mul_i32 s40, s42, 172032
    s_mul_i32 s41, s42, 6656
    s_add_u32 s51, s11, 16
    s_add_u32 s44, s44, 22
L_st_m:
L_st_mp:
    ds_read_b32 v11, v10
    s_waitcnt lgkmcnt(0)
    v_cmp_gt_u32 vcc, s51, v11
    s_cbranch_vccnz L_st_mp
    ds_read_b128 v[16:19], v12 offset:64
    v_add_u32 v12, s41, v12
    s_add_u32 s51, s51, 2
    s_waitcnt lgkmcnt(0)
    buffer_store_dwordx4 v[16:19], v5, s[24:27], s47 offen offset:64 sc0 sc1 nt
    s_add_u32 s47, s47, s40
    s_cmp_lt_u32 s51, s44
    s_cbranch_scc1 L_st_m
    s_cmp_eq_u32 s95, 1
    s_cselect_b32 s39, s43, s34
    s_cmp_eq_u32 s38, 1
    s_cselect_b32 s39, 5, s39
    s_sub_u32 s42, 0, s42
    s_mul_i32 s40, s11, s42
    s_add_u32 s39, s39, s40
    s_mul_i32 s47, s39, 86016
    s_add_u32 s47, s47, s45
    s_mul_i32 s48, s39, 3328
    v_add_u32 v12, s48, v2
    s_mul_i32 s40, s42, 172032
    s_mul_i32 s41, s42, 6656
    s_add_u32 s51, s11, 25
    s_and_b32 s38, s38, s11
    s_cbranch_scc0 L_st_go
    v_and_b32 v28, 3, v1
    v_mul_u32_u24 v28, 260, v28
    v_add_u32 v28, 160768, v28
    s_add_u32 s45, s45, 516096
L_st_s1:
    ds_read_b32 v11, v28
    s_waitcnt lgkmcnt(0)
    v_cmp_gt_u32 vcc, 24, v11
    s_cbranch_vccnz L_st_s1
    ds_read_b128 v[16:19], v2 offset:19968
    ds_read_b128 v[20:23], v2 offset:20096
    s_waitcnt lgkmcnt(1)
    buffer_store_dwordx4 v[16:19], v5, s[24:27], s45 offen offset:0 sc0 sc1 nt
    s_waitcnt lgkmcnt(0)
    buffer_store_dwordx4 v[20:23], v5, s[24:27], s45 offen offset:128 sc0 sc1 nt
L_st_go:
L_st_p1:
    ds_read_b32 v11, v10
    s_waitcnt lgkmcnt(0)
    v_cmp_gt_u32 vcc, s51, v11
    s_cbranch_vccnz L_st_p1
    ds_read_b128 v[16:19], v12 offset:0
    ds_read_b128 v[20:23], v12 offset:128
    v_add_u32 v12, s41, v12
    s_add_u32 s51, s51, 2
    s_waitcnt lgkmcnt(1)
    buffer_store_dwordx4 v[16:19], v5, s[24:27], s47 offen offset:0 sc0 sc1 nt
    s_waitcnt lgkmcnt(0)
    buffer_store_dwordx4 v[20:23], v5, s[24:27], s47 offen offset:128 sc0 sc1 nt
    s_add_u32 s47, s47, s40
    s_cmp_lt_u32 s51, 30
    s_cbranch_scc1 L_st_go
L_st_end:
L_exit:
    s_endpgm
L_compute:
    s_waitcnt lgkmcnt(0)
    s_barrier
    s_sub_u32 s37, s32, 4
    s_and_b32 s38, s37, 1
    s_lshr_b32 s37, s37, 1
    s_add_u32 s39, s34, 6
    s_mul_i32 s49, s37, s39
    v_mov_b32 v25, v30
    v_mov_b32 v27, 0
    v_and_b32 v32, 15, v1
    v_lshrrev_b32 v33, 4, v1
    v_and_b32 v34, 1, v33
    v_lshrrev_b32 v35, 1, v33
    v_bfe_u32 v36, v1, 2, 2
    v_and_b32 v37, 3, v1
    v_mul_u32_u24 v26, 260, v37
    v_add_u32 v26, 159744, v26
    v_or_b32 v16, 512, v26
    v_xor_b32 v17, 512, v16
    s_lshl_b32 s39, s38, 7
    v_lshlrev_b32 v40, 5, v34
    v_lshl_add_u32 v40, v35, 4, v40
    v_add_u32 v40, s39, v40
    s_lshl_b32 s39, s38, 5
    s_add_u32 s39, s39, 64
    v_lshlrev_b32 v41, 3, v33
    v_add_u32 v41, s39, v41
    v_mul_u32_u24 v38, 384, v32
    v_add_u32 v38, s36, v38
    v_add_u32 v7, v38, v40
    v_add_u32 v8, v38, v41
    v_mul_u32_u24 v38, 208, v32
    s_mul_i32 s39, s49, 3328
    v_add_u32 v38, s39, v38
    s_lshl_b32 s39, s38, 7
    v_lshl_add_u32 v9, v33, 3, v38
    v_add_u32 v9, s39, v9
    v_add_u32 v10, v38, v41
    s_mul_i32 s47, s49, 86016
    s_add_u32 s47, s47, s35
    v_lshl_add_u32 v38, v33, 3, v36
    v_mul_u32_u24 v38, 192, v38
    v_lshl_add_u32 v38, v37, 3, v38
    v_add_u32 v38, 67584, v38
    s_add_u32 s39, s38, 2
    v_xor_b32 v39, s39, v34
    v_lshl_add_u32 v4, v39, 5, v38
    s_lshl_b32 s39, s38, 2
    v_xor_b32 v39, s39, v34
    v_lshl_add_u32 v5, v39, 5, v38
    v_xor_b32 v39, 1, v39
    v_lshl_add_u32 v6, v39, 5, v38
    v_lshlrev_b32 v38, 6, v32
    v_lshl_add_u32 v38, v33, 4, v38
    s_mul_i32 s39, s49, 1280
    v_add_u32 v1, s39, v38
    v_lshrrev_b32 v11, 3, v1
    v_and_b32 v11, 32, v11
    v_xor_b32 v2, v1, v11
    v_xor_b32 v3, 32, v2
    v_mov_b64 v[136:137], 0
    v_mov_b64 v[138:139], 0
    v_mov_b64 v[140:141], 0
    v_mov_b64 v[142:143], 0
    v_mov_b64 v[144:145], 0
    v_mov_b64 v[146:147], 0
    v_mov_b64 v[148:149], 0
    v_mov_b64 v[150:151], 0
    v_mov_b64 v[152:153], 0
    v_mov_b64 v[154:155], 0
    v_mov_b64 v[156:157], 0
    v_mov_b64 v[158:159], 0
    v_mov_b64 v[160:161], 0
    v_mov_b64 v[162:163], 0
    v_mov_b64 v[164:165], 0
    v_mov_b64 v[166:167], 0
    v_mov_b64 v[168:169], 0
    v_mov_b64 v[170:171], 0
    v_mov_b64 v[172:173], 0
    v_mov_b64 v[174:175], 0
    v_mov_b64 v[176:177], 0
    v_mov_b64 v[178:179], 0
    v_mov_b64 v[180:181], 0
    v_mov_b64 v[182:183], 0
    v_mov_b64 v[184:185], 0
    v_mov_b64 v[186:187], 0
    v_mov_b64 v[188:189], 0
    v_mov_b64 v[190:191], 0
    v_mov_b64 v[192:193], 0
    v_mov_b64 v[194:195], 0
    v_mov_b64 v[196:197], 0
    v_mov_b64 v[198:199], 0
    v_mov_b64 v[200:201], 0
    v_mov_b64 v[202:203], 0
    v_mov_b64 v[204:205], 0
    v_mov_b64 v[206:207], 0
    v_mov_b64 v[208:209], 0
    v_mov_b64 v[210:211], 0
    v_mov_b64 v[212:213], 0
    v_mov_b64 v[214:215], 0
    v_mov_b64 v[216:217], 0
    v_mov_b64 v[218:219], 0
    s_mov_b32 s40, 2112
    s_mov_b32 s41, 9360
    s_mov_b32 s44, 4294905856
    s_mov_b32 s45, 30720
    s_mov_b32 s46, 2
    s_mov_b32 s26, 9633792
    s_mov_b32 s27, 0x20000
    s_setprio 1
    s_cmp_eq_u32 s31, 1
    s_cbranch_scc1 L_pro1
    s_cmp_eq_u32 s31, 2
    s_cbranch_scc1 L_pro2
    s_cmp_eq_u32 s31, 3
    s_cbranch_scc1 L_pro3
    s_branch L_pro0
    .p2align 12
L_pro0:
L_p0_0:
    ds_read_b32 v28, v16
    s_waitcnt lgkmcnt(0)
    v_cmp_gt_u32 vcc, 1, v28
    s_cbranch_vccnz L_p0_0
    ds_read_b128 v[32:35], v2 offset:0
    ds_read_b128 v[36:39], v3 offset:1280
    ds_read_b128 v[40:43], v2 offset:2560
    ds_read_b128 v[44:47], v3 offset:3840
    ds_read_b128 v[48:51], v2 offset:5120
    ds_read_b128 v[52:55], v3 offset:6400
    ds_read_b128 v[56:59], v2 offset:7680
    ds_read_b128 v[60:63], v3 offset:8960
    ds_read_b128 v[64:67], v2 offset:10240
    ds_read_b128 v[68:71], v3 offset:11520
    ds_read_b128 v[72:75], v2 offset:12800
L_p1_0:
    ds_read_b32 v28, v17
    s_waitcnt lgkmcnt(0)
    v_cmp_gt_u32 vcc, 1, v28
    s_cbranch_vccnz L_p1_0
    ds_read_b64_tr_b16 v[76:77], v4 offset:0
    ds_read_b64_tr_b16 v[78:79], v4 offset:768
    ds_read_b64_tr_b16 v[88:89], v4 offset:6144
    ds_read_b64_tr_b16 v[90:91], v4 offset:6912
    ds_read_b64_tr_b16 v[100:101], v4 offset:12288
    ds_read_b64_tr_b16 v[102:103], v4 offset:13056
    ds_read_b64_tr_b16 v[112:113], v4 offset:18432
    ds_read_b64_tr_b16 v[114:115], v4 offset:19200
    ds_read_b64_tr_b16 v[124:125], v4 offset:24576
    ds_read_b64_tr_b16 v[126:127], v4 offset:25344
    ds_read_b64_tr_b16 v[80:81], v5 offset:0
    ds_read_b64_tr_b16 v[82:83], v5 offset:768
    ds_read_b64_tr_b16 v[92:93], v5 offset:6144
    ds_read_b64_tr_b16 v[94:95], v5 offset:6912
    ds_read_b64_tr_b16 v[104:105], v5 offset:12288
    ds_read_b64_tr_b16 v[106:107], v5 offset:13056
    ds_read_b64_tr_b16 v[116:117], v5 offset:18432
    ds_read_b64_tr_b16 v[118:119], v5 offset:19200
    ds_read_b64_tr_b16 v[128:129], v5 offset:24576
    ds_read_b64_tr_b16 v[130:131], v5 offset:25344
    s_waitcnt lgkmcnt(14)
    s_branch L_head0
    .p2align 6
L_pad0:
    s_branch L_compute
    s_nop 0
L_top0:
    ds_read_b64_tr_b16 v[76:77], v4 offset:0
    v_mfma_f32_16x16x32_bf16 v[212:215], v[116:119], v[68:71], v[212:215]
    ds_read_b64_tr_b16 v[78:79], v4 offset:768
    v_mfma_f32_16x16x32_bf16 v[212:215], v[128:131], v[72:75], v[212:215]
    ds_read_b64_tr_b16 v[88:89], v4 offset:6144
    v_mfma_f32_16x16x32_bf16 v[144:147], v[132:135], v[48:51], v[144:147]
    ds_read_b64_tr_b16 v[90:91], v4 offset:6912
    v_mfma_f32_16x16x32_bf16 v[144:147], v[120:123], v[44:47], v[144:147]
    ds_read_b64_tr_b16 v[100:101], v4 offset:12288
    v_mfma_f32_16x16x32_bf16 v[144:147], v[108:111], v[40:43], v[144:147]
    ds_read_b64_tr_b16 v[102:103], v4 offset:13056
    v_mfma_f32_16x16x32_bf16 v[144:147], v[96:99], v[36:39], v[144:147]
    ds_read_b64_tr_b16 v[112:113], v4 offset:18432
    v_mfma_f32_16x16x32_bf16 v[144:147], v[84:87], v[32:35], v[144:147]
    ds_read_b128 v[32:35], v2 offset:0
    v_mfma_f32_16x16x32_bf16 v[156:159], v[84:87], v[36:39], v[156:159]
    ds_read_b128 v[36:39], v3 offset:1280
    v_mfma_f32_16x16x32_bf16 v[156:159], v[96:99], v[40:43], v[156:159]
    ds_read_b64_tr_b16 v[114:115], v4 offset:19200
    v_mfma_f32_16x16x32_bf16 v[156:159], v[108:111], v[44:47], v[156:159]
    ds_read_b64_tr_b16 v[124:125], v4 offset:24576
    v_mfma_f32_16x16x32_bf16 v[156:159], v[120:123], v[48:51], v[156:159]
    ds_read_b64_tr_b16 v[126:127], v4 offset:25344
    v_mfma_f32_16x16x32_bf16 v[156:159], v[132:135], v[52:55], v[156:159]
    ds_read_b64_tr_b16 v[80:81], v5 offset:0
    v_mfma_f32_16x16x32_bf16 v[168:171], v[132:135], v[56:59], v[168:171]
    ds_read_b64_tr_b16 v[82:83], v5 offset:768
    v_mfma_f32_16x16x32_bf16 v[168:171], v[120:123], v[52:55], v[168:171]
    ds_read_b64_tr_b16 v[92:93], v5 offset:6144
    v_mfma_f32_16x16x32_bf16 v[168:171], v[108:111], v[48:51], v[168:171]
    ds_read_b64_tr_b16 v[94:95], v5 offset:6912
    v_mfma_f32_16x16x32_bf16 v[168:171], v[96:99], v[44:47], v[168:171]
    ds_read_b64_tr_b16 v[104:105], v5 offset:12288
    v_mfma_f32_16x16x32_bf16 v[168:171], v[84:87], v[40:43], v[168:171]
    ds_read_b128 v[40:43], v2 offset:2560
    v_mfma_f32_16x16x32_bf16 v[180:183], v[84:87], v[44:47], v[180:183]
    ds_read_b128 v[44:47], v3 offset:3840
    v_mfma_f32_16x16x32_bf16 v[180:183], v[96:99], v[48:51], v[180:183]
    ds_read_b64_tr_b16 v[106:107], v5 offset:13056
    v_mfma_f32_16x16x32_bf16 v[180:183], v[108:111], v[52:55], v[180:183]
    ds_read_b64_tr_b16 v[116:117], v5 offset:18432
    v_mfma_f32_16x16x32_bf16 v[180:183], v[120:123], v[56:59], v[180:183]
    ds_read_b64_tr_b16 v[118:119], v5 offset:19200
    v_mfma_f32_16x16x32_bf16 v[180:183], v[132:135], v[60:63], v[180:183]
    ds_read_b64_tr_b16 v[128:129], v5 offset:24576
    v_mfma_f32_16x16x32_bf16 v[192:195], v[132:135], v[64:67], v[192:195]
    ds_read_b64_tr_b16 v[130:131], v5 offset:25344
    v_mfma_f32_16x16x32_bf16 v[192:195], v[120:123], v[60:63], v[192:195]
    ds_read_b128 v[72:75], v2 offset:12800
    s_add_u32 s46, s46, 1
    v_mfma_f32_16x16x32_bf16 v[192:195], v[108:111], v[56:59], v[192:195]
    v_mfma_f32_16x16x32_bf16 v[192:195], v[96:99], v[52:55], v[192:195]
    v_mfma_f32_16x16x32_bf16 v[192:195], v[84:87], v[48:51], v[192:195]
    ds_read_b128 v[48:51], v2 offset:5120
    v_mfma_f32_16x16x32_bf16 v[204:207], v[84:87], v[52:55], v[204:207]
    ds_read_b128 v[52:55], v3 offset:6400
    v_mfma_f32_16x16x32_bf16 v[204:207], v[96:99], v[56:59], v[204:207]
    ds_read_b128 v[56:59], v2 offset:7680
    v_mfma_f32_16x16x32_bf16 v[204:207], v[108:111], v[60:63], v[204:207]
    ds_read_b128 v[60:63], v3 offset:8960
    v_mfma_f32_16x16x32_bf16 v[204:207], v[120:123], v[64:67], v[204:207]
    ds_read_b128 v[64:67], v2 offset:10240
    v_mfma_f32_16x16x32_bf16 v[204:207], v[132:135], v[68:71], v[204:207]
    ds_read_b128 v[68:71], v3 offset:11520
L_head0:
    s_waitcnt lgkmcnt(6)
    v_mfma_f32_16x16x32_bf16 v[136:139], v[76:79], v[32:35], v[136:139]
    ds_read_b64_tr_b16 v[132:133], v6 offset:24576
    v_mfma_f32_16x16x32_bf16 v[136:139], v[88:91], v[36:39], v[136:139]
    ds_read_b64_tr_b16 v[134:135], v6 offset:25344
    v_mfma_f32_16x16x32_bf16 v[136:139], v[100:103], v[40:43], v[136:139]
    ds_read_b64_tr_b16 v[120:121], v6 offset:18432
    v_mfma_f32_16x16x32_bf16 v[136:139], v[112:115], v[44:47], v[136:139]
    ds_read_b64_tr_b16 v[122:123], v6 offset:19200
    s_waitcnt lgkmcnt(8)
    v_mfma_f32_16x16x32_bf16 v[136:139], v[124:127], v[48:51], v[136:139]
    ds_read_b64_tr_b16 v[108:109], v6 offset:12288
    v_mfma_f32_16x16x32_bf16 v[148:151], v[124:127], v[52:55], v[148:151]
    ds_read_b64_tr_b16 v[110:111], v6 offset:13056
    v_mfma_f32_16x16x32_bf16 v[148:151], v[112:115], v[48:51], v[148:151]
    ds_read_b64_tr_b16 v[96:97], v6 offset:6144
    v_mfma_f32_16x16x32_bf16 v[148:151], v[100:103], v[44:47], v[148:151]
    ds_read_b64_tr_b16 v[98:99], v6 offset:6912
    v_mfma_f32_16x16x32_bf16 v[148:151], v[88:91], v[40:43], v[148:151]
    ds_read_b64_tr_b16 v[84:85], v6 offset:0
    v_mfma_f32_16x16x32_bf16 v[148:151], v[76:79], v[36:39], v[148:151]
    v_add_u32 v27, 1, v27
    ds_read_b64_tr_b16 v[86:87], v6 offset:768
    v_mfma_f32_16x16x32_bf16 v[160:163], v[76:79], v[40:43], v[160:163]
    ds_write_b32 v25, v27
    v_mfma_f32_16x16x32_bf16 v[160:163], v[88:91], v[44:47], v[160:163]
    v_mfma_f32_16x16x32_bf16 v[160:163], v[100:103], v[48:51], v[160:163]
    s_bitcmp1_b32 s40, s46
    v_mfma_f32_16x16x32_bf16 v[160:163], v[112:115], v[52:55], v[160:163]
    s_cselect_b32 s42, 22272, 64
    s_waitcnt lgkmcnt(5)
    v_mfma_f32_16x16x32_bf16 v[160:163], v[124:127], v[56:59], v[160:163]
    s_bitcmp1_b32 s41, s46
    v_mfma_f32_16x16x32_bf16 v[172:175], v[124:127], v[60:63], v[172:175]
    s_cselect_b32 s43, s44, s45
    v_mfma_f32_16x16x32_bf16 v[172:175], v[112:115], v[56:59], v[172:175]
    s_cmp_eq_u32 s46, 14
    v_mfma_f32_16x16x32_bf16 v[172:175], v[100:103], v[52:55], v[172:175]
    s_cselect_b32 s49, 1000, s46
    v_mfma_f32_16x16x32_bf16 v[172:175], v[88:91], v[48:51], v[172:175]
    v_add_u32 v1, s42, v1
    v_mfma_f32_16x16x32_bf16 v[172:175], v[76:79], v[44:47], v[172:175]
    v_lshrrev_b32 v11, 3, v1
    v_mfma_f32_16x16x32_bf16 v[184:187], v[76:79], v[48:51], v[184:187]
    v_and_b32 v11, 32, v11
    v_mfma_f32_16x16x32_bf16 v[184:187], v[88:91], v[52:55], v[184:187]
    v_xor_b32 v2, v1, v11
    v_mfma_f32_16x16x32_bf16 v[184:187], v[100:103], v[56:59], v[184:187]
    v_xor_b32 v3, 32, v2
    v_mfma_f32_16x16x32_bf16 v[184:187], v[112:115], v[60:63], v[184:187]
    v_add_u32 v4, s43, v4
    v_mfma_f32_16x16x32_bf16 v[184:187], v[124:127], v[64:67], v[184:187]
    v_add_u32 v5, s43, v5
    v_mfma_f32_16x16x32_bf16 v[196:199], v[124:127], v[68:71], v[196:199]
    v_add_u32 v6, s43, v6
    v_mfma_f32_16x16x32_bf16 v[196:199], v[112:115], v[64:67], v[196:199]
    v_mfma_f32_16x16x32_bf16 v[196:199], v[100:103], v[60:63], v[196:199]
    v_mfma_f32_16x16x32_bf16 v[196:199], v[88:91], v[56:59], v[196:199]
    v_mfma_f32_16x16x32_bf16 v[196:199], v[76:79], v[52:55], v[196:199]
    v_mfma_f32_16x16x32_bf16 v[140:143], v[80:83], v[32:35], v[140:143]
    v_mfma_f32_16x16x32_bf16 v[140:143], v[92:95], v[36:39], v[140:143]
    v_mfma_f32_16x16x32_bf16 v[140:143], v[104:107], v[40:43], v[140:143]
    v_mfma_f32_16x16x32_bf16 v[140:143], v[116:119], v[44:47], v[140:143]
    v_mfma_f32_16x16x32_bf16 v[140:143], v[128:131], v[48:51], v[140:143]
    v_mfma_f32_16x16x32_bf16 v[152:155], v[128:131], v[52:55], v[152:155]
    v_mfma_f32_16x16x32_bf16 v[152:155], v[116:119], v[48:51], v[152:155]
    v_mfma_f32_16x16x32_bf16 v[152:155], v[104:107], v[44:47], v[152:155]
    v_mfma_f32_16x16x32_bf16 v[152:155], v[92:95], v[40:43], v[152:155]
    v_mfma_f32_16x16x32_bf16 v[152:155], v[80:83], v[36:39], v[152:155]
    v_mfma_f32_16x16x32_bf16 v[164:167], v[80:83], v[40:43], v[164:167]
    v_mfma_f32_16x16x32_bf16 v[164:167], v[92:95], v[44:47], v[164:167]
    v_mfma_f32_16x16x32_bf16 v[164:167], v[104:107], v[48:51], v[164:167]
    v_mfma_f32_16x16x32_bf16 v[164:167], v[116:119], v[52:55], v[164:167]
    v_mfma_f32_16x16x32_bf16 v[164:167], v[128:131], v[56:59], v[164:167]
    v_mfma_f32_16x16x32_bf16 v[176:179], v[128:131], v[60:63], v[176:179]
    v_mfma_f32_16x16x32_bf16 v[176:179], v[116:119], v[56:59], v[176:179]
    v_mfma_f32_16x16x32_bf16 v[176:179], v[104:107], v[52:55], v[176:179]
    v_mfma_f32_16x16x32_bf16 v[176:179], v[92:95], v[48:51], v[176:179]
    v_mfma_f32_16x16x32_bf16 v[176:179], v[80:83], v[44:47], v[176:179]
    ds_read_b32 v28, v26
    v_mfma_f32_16x16x32_bf16 v[188:191], v[80:83], v[48:51], v[188:191]
    v_mfma_f32_16x16x32_bf16 v[188:191], v[92:95], v[52:55], v[188:191]
    v_mfma_f32_16x16x32_bf16 v[188:191], v[104:107], v[56:59], v[188:191]
    v_mfma_f32_16x16x32_bf16 v[188:191], v[116:119], v[60:63], v[188:191]
    v_mfma_f32_16x16x32_bf16 v[188:191], v[128:131], v[64:67], v[188:191]
    v_mfma_f32_16x16x32_bf16 v[200:203], v[128:131], v[68:71], v[200:203]
    v_mfma_f32_16x16x32_bf16 v[200:203], v[116:119], v[64:67], v[200:203]
    v_mfma_f32_16x16x32_bf16 v[200:203], v[104:107], v[60:63], v[200:203]
    s_waitcnt lgkmcnt(0)
    v_mfma_f32_16x16x32_bf16 v[200:203], v[92:95], v[56:59], v[200:203]
    v_cmp_gt_u32 vcc, s49, v28
    v_mfma_f32_16x16x32_bf16 v[200:203], v[80:83], v[52:55], v[200:203]
    v_mfma_f32_16x16x32_bf16 v[212:215], v[80:83], v[56:59], v[212:215]
    v_mfma_f32_16x16x32_bf16 v[212:215], v[92:95], v[60:63], v[212:215]
    v_mfma_f32_16x16x32_bf16 v[212:215], v[104:107], v[64:67], v[212:215]
    s_cbranch_vccz L_top0
    s_min_u32 s49, s49, 15
    v_cmp_gt_u32 vcc, s49, v28
    s_cbranch_vccz L_fin0
L_slow0:
    ds_read_b32 v28, v26
    s_waitcnt lgkmcnt(0)
    v_cmp_gt_u32 vcc, s49, v28
    s_cbranch_vccnz L_slow0
    s_cmp_eq_u32 s46, 14
    s_cbranch_scc1 L_fin0
    s_branch L_top0
L_pro1:
L_p0_1:
    ds_read_b32 v28, v16
    s_waitcnt lgkmcnt(0)
    v_cmp_gt_u32 vcc, 1, v28
    s_cbranch_vccnz L_p0_1
    ds_read_b128 v[32:35], v2 offset:0
    ds_read_b128 v[36:39], v3 offset:1280
    ds_read_b128 v[40:43], v2 offset:2560
    ds_read_b128 v[44:47], v3 offset:3840
    ds_read_b128 v[48:51], v2 offset:5120
    ds_read_b128 v[52:55], v3 offset:6400
    ds_read_b128 v[56:59], v2 offset:7680
    ds_read_b128 v[60:63], v3 offset:8960
    ds_read_b128 v[64:67], v2 offset:10240
    ds_read_b128 v[68:71], v3 offset:11520
    ds_read_b128 v[72:75], v2 offset:12800
L_p1_1:
    ds_read_b32 v28, v17
    s_waitcnt lgkmcnt(0)
    v_cmp_gt_u32 vcc, 1, v28
    s_cbranch_vccnz L_p1_1
    ds_read_b64_tr_b16 v[76:77], v4 offset:0
    ds_read_b64_tr_b16 v[78:79], v4 offset:768
    ds_read_b64_tr_b16 v[88:89], v4 offset:6144
    ds_read_b64_tr_b16 v[90:91], v4 offset:6912
    ds_read_b64_tr_b16 v[100:101], v4 offset:12288
    ds_read_b64_tr_b16 v[102:103], v4 offset:13056
    ds_read_b64_tr_b16 v[112:113], v4 offset:18432
    ds_read_b64_tr_b16 v[114:115], v4 offset:19200
    ds_read_b64_tr_b16 v[124:125], v4 offset:24576
    ds_read_b64_tr_b16 v[126:127], v4 offset:25344
    ds_read_b64_tr_b16 v[80:81], v5 offset:0
    ds_read_b64_tr_b16 v[82:83], v5 offset:768
    ds_read_b64_tr_b16 v[92:93], v5 offset:6144
    ds_read_b64_tr_b16 v[94:95], v5 offset:6912
    ds_read_b64_tr_b16 v[104:105], v5 offset:12288
    ds_read_b64_tr_b16 v[106:107], v5 offset:13056
    ds_read_b64_tr_b16 v[116:117], v5 offset:18432
    ds_read_b64_tr_b16 v[118:119], v5 offset:19200
    ds_read_b64_tr_b16 v[128:129], v5 offset:24576
    ds_read_b64_tr_b16 v[130:131], v5 offset:25344
    s_waitcnt lgkmcnt(14)
    s_branch L_head1
    .p2align 6
L_pad1:
    s_branch L_compute
    s_nop 0
L_top1:
    ds_read_b64_tr_b16 v[76:77], v4 offset:0
    v_mfma_f32_16x16x32_bf16 v[144:147], v[96:99], v[36:39], v[144:147]
    ds_read_b64_tr_b16 v[78:79], v4 offset:768
    v_mfma_f32_16x16x32_bf16 v[144:147], v[84:87], v[32:35], v[144:147]
    ds_read_b128 v[32:35], v2 offset:0
    v_mfma_f32_16x16x32_bf16 v[156:159], v[84:87], v[36:39], v[156:159]
    ds_read_b64_tr_b16 v[88:89], v4 offset:6144
    v_mfma_f32_16x16x32_bf16 v[156:159], v[96:99], v[40:43], v[156:159]
    ds_read_b64_tr_b16 v[90:91], v4 offset:6912
    v_mfma_f32_16x16x32_bf16 v[156:159], v[108:111], v[44:47], v[156:159]
    ds_read_b128 v[36:39], v3 offset:1280
    v_mfma_f32_16x16x32_bf16 v[156:159], v[120:123], v[48:51], v[156:159]
    ds_read_b64_tr_b16 v[100:101], v4 offset:12288
    v_mfma_f32_16x16x32_bf16 v[156:159], v[132:135], v[52:55], v[156:159]
    ds_read_b64_tr_b16 v[102:103], v4 offset:13056
    v_mfma_f32_16x16x32_bf16 v[168:171], v[132:135], v[56:59], v[168:171]
    ds_read_b64_tr_b16 v[112:113], v4 offset:18432
    v_mfma_f32_16x16x32_bf16 v[168:171], v[120:123], v[52:55], v[168:171]
    ds_read_b64_tr_b16 v[114:115], v4 offset:19200
    v_mfma_f32_16x16x32_bf16 v[168:171], v[108:111], v[48:51], v[168:171]
    ds_read_b64_tr_b16 v[124:125], v4 offset:24576
    v_mfma_f32_16x16x32_bf16 v[168:171], v[96:99], v[44:47], v[168:171]
    ds_read_b64_tr_b16 v[126:127], v4 offset:25344
    v_mfma_f32_16x16x32_bf16 v[168:171], v[84:87], v[40:43], v[168:171]
    ds_read_b128 v[40:43], v2 offset:2560
    v_mfma_f32_16x16x32_bf16 v[180:183], v[84:87], v[44:47], v[180:183]
    ds_read_b128 v[44:47], v3 offset:3840
    v_mfma_f32_16x16x32_bf16 v[180:183], v[96:99], v[48:51], v[180:183]
    ds_read_b64_tr_b16 v[80:81], v5 offset:0
    v_mfma_f32_16x16x32_bf16 v[180:183], v[108:111], v[52:55], v[180:183]
    ds_read_b64_tr_b16 v[82:83], v5 offset:768
    v_mfma_f32_16x16x32_bf16 v[180:183], v[120:123], v[56:59], v[180:183]
    ds_read_b64_tr_b16 v[92:93], v5 offset:6144
    v_mfma_f32_16x16x32_bf16 v[180:183], v[132:135], v[60:63], v[180:183]
    ds_read_b64_tr_b16 v[94:95], v5 offset:6912
    v_mfma_f32_16x16x32_bf16 v[192:195], v[132:135], v[64:67], v[192:195]
    ds_read_b64_tr_b16 v[104:105], v5 offset:12288
    v_mfma_f32_16x16x32_bf16 v[192:195], v[120:123], v[60:63], v[192:195]
    ds_read_b64_tr_b16 v[106:107], v5 offset:13056
    v_mfma_f32_16x16x32_bf16 v[192:195], v[108:111], v[56:59], v[192:195]
    ds_read_b64_tr_b16 v[116:117], v5 offset:18432
    v_mfma_f32_16x16x32_bf16 v[192:195], v[96:99], v[52:55], v[192:195]
    ds_read_b64_tr_b16 v[118:119], v5 offset:19200
    v_mfma_f32_16x16x32_bf16 v[192:195], v[84:87], v[48:51], v[192:195]
    ds_read_b128 v[48:51], v2 offset:5120
    v_mfma_f32_16x16x32_bf16 v[204:207], v[84:87], v[52:55], v[204:207]
    ds_read_b128 v[52:55], v3 offset:6400
    v_mfma_f32_16x16x32_bf16 v[204:207], v[96:99], v[56:59], v[204:207]
    ds_read_b64_tr_b16 v[128:129], v5 offset:24576
    s_add_u32 s46, s46, 1
    v_mfma_f32_16x16x32_bf16 v[204:207], v[108:111], v[60:63], v[204:207]
    ds_read_b64_tr_b16 v[130:131], v5 offset:25344
    v_mfma_f32_16x16x32_bf16 v[204:207], v[120:123], v[64:67], v[204:207]
    v_mfma_f32_16x16x32_bf16 v[204:207], v[132:135], v[68:71], v[204:207]
    v_mfma_f32_16x16x32_bf16 v[216:219], v[132:135], v[72:75], v[216:219]
    ds_read_b128 v[72:75], v2 offset:12800
    v_mfma_f32_16x16x32_bf16 v[216:219], v[120:123], v[68:71], v[216:219]
    ds_read_b128 v[68:71], v3 offset:11520
    v_mfma_f32_16x16x32_bf16 v[216:219], v[108:111], v[64:67], v[216:219]
    ds_read_b128 v[64:67], v2 offset:10240
    v_mfma_f32_16x16x32_bf16 v[216:219], v[96:99], v[60:63], v[216:219]
    ds_read_b128 v[60:63], v3 offset:8960
    v_mfma_f32_16x16x32_bf16 v[216:219], v[84:87], v[56:59], v[216:219]
    ds_read_b128 v[56:59], v2 offset:7680
L_head1:
    s_waitcnt lgkmcnt(6)
    v_mfma_f32_16x16x32_bf16 v[136:139], v[76:79], v[32:35], v[136:139]
    ds_read_b64_tr_b16 v[132:133], v6 offset:24576
    v_mfma_f32_16x16x32_bf16 v[136:139], v[88:91], v[36:39], v[136:139]
    ds_read_b64_tr_b16 v[134:135], v6 offset:25344
    v_mfma_f32_16x16x32_bf16 v[136:139], v[100:103], v[40:43], v[136:139]
    ds_read_b64_tr_b16 v[120:121], v6 offset:18432
    v_mfma_f32_16x16x32_bf16 v[136:139], v[112:115], v[44:47], v[136:139]
    ds_read_b64_tr_b16 v[122:123], v6 offset:19200
    v_mfma_f32_16x16x32_bf16 v[136:139], v[124:127], v[48:51], v[136:139]
    ds_read_b64_tr_b16 v[108:109], v6 offset:12288
    v_mfma_f32_16x16x32_bf16 v[148:151], v[124:127], v[52:55], v[148:151]
    ds_read_b64_tr_b16 v[110:111], v6 offset:13056
    v_mfma_f32_16x16x32_bf16 v[148:151], v[112:115], v[48:51], v[148:151]
    ds_read_b64_tr_b16 v[96:97], v6 offset:6144
    v_mfma_f32_16x16x32_bf16 v[148:151], v[100:103], v[44:47], v[148:151]
    ds_read_b64_tr_b16 v[98:99], v6 offset:6912
    v_mfma_f32_16x16x32_bf16 v[148:151], v[88:91], v[40:43], v[148:151]
    ds_read_b64_tr_b16 v[84:85], v6 offset:0
    v_mfma_f32_16x16x32_bf16 v[148:151], v[76:79], v[36:39], v[148:151]
    v_add_u32 v27, 1, v27
    ds_read_b64_tr_b16 v[86:87], v6 offset:768
    v_mfma_f32_16x16x32_bf16 v[160:163], v[76:79], v[40:43], v[160:163]
    ds_write_b32 v25, v27
    v_mfma_f32_16x16x32_bf16 v[160:163], v[88:91], v[44:47], v[160:163]
    v_mfma_f32_16x16x32_bf16 v[160:163], v[100:103], v[48:51], v[160:163]
    s_bitcmp1_b32 s40, s46
    v_mfma_f32_16x16x32_bf16 v[160:163], v[112:115], v[52:55], v[160:163]
    s_cselect_b32 s42, 22272, 64
    s_waitcnt lgkmcnt(5)
    v_mfma_f32_16x16x32_bf16 v[160:163], v[124:127], v[56:59], v[160:163]
    s_bitcmp1_b32 s41, s46
    v_mfma_f32_16x16x32_bf16 v[172:175], v[124:127], v[60:63], v[172:175]
    s_cselect_b32 s43, s44, s45
    v_mfma_f32_16x16x32_bf16 v[172:175], v[112:115], v[56:59], v[172:175]
    s_cmp_eq_u32 s46, 14
    v_mfma_f32_16x16x32_bf16 v[172:175], v[100:103], v[52:55], v[172:175]
    s_cselect_b32 s49, 1000, s46
    v_mfma_f32_16x16x32_bf16 v[172:175], v[88:91], v[48:51], v[172:175]
    v_add_u32 v1, s42, v1
    v_mfma_f32_16x16x32_bf16 v[172:175], v[76:79], v[44:47], v[172:175]
    v_lshrrev_b32 v11, 3, v1
    v_mfma_f32_16x16x32_bf16 v[184:187], v[76:79], v[48:51], v[184:187]
    v_and_b32 v11, 32, v11
    v_mfma_f32_16x16x32_bf16 v[184:187], v[88:91], v[52:55], v[184:187]
    v_xor_b32 v2, v1, v11
    v_mfma_f32_16x16x32_bf16 v[184:187], v[100:103], v[56:59], v[184:187]
    v_xor_b32 v3, 32, v2
    v_mfma_f32_16x16x32_bf16 v[184:187], v[112:115], v[60:63], v[184:187]
    v_add_u32 v4, s43, v4
    v_mfma_f32_16x16x32_bf16 v[184:187], v[124:127], v[64:67], v[184:187]
    v_add_u32 v5, s43, v5
    v_mfma_f32_16x16x32_bf16 v[196:199], v[124:127], v[68:71], v[196:199]
    v_add_u32 v6, s43, v6
    v_mfma_f32_16x16x32_bf16 v[196:199], v[112:115], v[64:67], v[196:199]
    v_mfma_f32_16x16x32_bf16 v[196:199], v[100:103], v[60:63], v[196:199]
    v_mfma_f32_16x16x32_bf16 v[196:199], v[88:91], v[56:59], v[196:199]
    v_mfma_f32_16x16x32_bf16 v[196:199], v[76:79], v[52:55], v[196:199]
    v_mfma_f32_16x16x32_bf16 v[152:155], v[80:83], v[36:39], v[152:155]
    v_mfma_f32_16x16x32_bf16 v[152:155], v[92:95], v[40:43], v[152:155]
    v_mfma_f32_16x16x32_bf16 v[152:155], v[104:107], v[44:47], v[152:155]
    v_mfma_f32_16x16x32_bf16 v[152:155], v[116:119], v[48:51], v[152:155]
    v_mfma_f32_16x16x32_bf16 v[152:155], v[128:131], v[52:55], v[152:155]
    v_mfma_f32_16x16x32_bf16 v[164:167], v[128:131], v[56:59], v[164:167]
    v_mfma_f32_16x16x32_bf16 v[164:167], v[116:119], v[52:55], v[164:167]
    v_mfma_f32_16x16x32_bf16 v[164:167], v[104:107], v[48:51], v[164:167]
    v_mfma_f32_16x16x32_bf16 v[164:167], v[92:95], v[44:47], v[164:167]
    v_mfma_f32_16x16x32_bf16 v[164:167], v[80:83], v[40:43], v[164:167]
    v_mfma_f32_16x16x32_bf16 v[176:179], v[80:83], v[44:47], v[176:179]
    v_mfma_f32_16x16x32_bf16 v[176:179], v[92:95], v[48:51], v[176:179]
    v_mfma_f32_16x16x32_bf16 v[176:179], v[104:107], v[52:55], v[176:179]
    v_mfma_f32_16x16x32_bf16 v[176:179], v[116:119], v[56:59], v[176:179]
    v_mfma_f32_16x16x32_bf16 v[176:179], v[128:131], v[60:63], v[176:179]
    v_mfma_f32_16x16x32_bf16 v[188:191], v[128:131], v[64:67], v[188:191]
    v_mfma_f32_16x16x32_bf16 v[188:191], v[116:119], v[60:63], v[188:191]
    v_mfma_f32_16x16x32_bf16 v[188:191], v[104:107], v[56:59], v[188:191]
    v_mfma_f32_16x16x32_bf16 v[188:191], v[92:95], v[52:55], v[188:191]
    v_mfma_f32_16x16x32_bf16 v[188:191], v[80:83], v[48:51], v[188:191]
    ds_read_b32 v28, v26
    v_mfma_f32_16x16x32_bf16 v[200:203], v[80:83], v[52:55], v[200:203]
    v_mfma_f32_16x16x32_bf16 v[200:203], v[92:95], v[56:59], v[200:203]
    v_mfma_f32_16x16x32_bf16 v[200:203], v[104:107], v[60:63], v[200:203]
    v_mfma_f32_16x16x32_bf16 v[200:203], v[116:119], v[64:67], v[200:203]
    v_mfma_f32_16x16x32_bf16 v[200:203], v[128:131], v[68:71], v[200:203]
    v_mfma_f32_16x16x32_bf16 v[212:215], v[128:131], v[72:75], v[212:215]
    v_mfma_f32_16x16x32_bf16 v[212:215], v[116:119], v[68:71], v[212:215]
    v_mfma_f32_16x16x32_bf16 v[212:215], v[104:107], v[64:67], v[212:215]
    s_waitcnt lgkmcnt(0)
    v_mfma_f32_16x16x32_bf16 v[212:215], v[92:95], v[60:63], v[212:215]
    v_cmp_gt_u32 vcc, s49, v28
    v_mfma_f32_16x16x32_bf16 v[212:215], v[80:83], v[56:59], v[212:215]
    v_mfma_f32_16x16x32_bf16 v[144:147], v[132:135], v[48:51], v[144:147]
    v_mfma_f32_16x16x32_bf16 v[144:147], v[120:123], v[44:47], v[144:147]
    v_mfma_f32_16x16x32_bf16 v[144:147], v[108:111], v[40:43], v[144:147]
    s_cbranch_vccz L_top1
    s_min_u32 s49, s49, 15
    v_cmp_gt_u32 vcc, s49, v28
    s_cbranch_vccz L_fin1
L_slow1:
    ds_read_b32 v28, v26
    s_waitcnt lgkmcnt(0)
    v_cmp_gt_u32 vcc, s49, v28
    s_cbranch_vccnz L_slow1
    s_cmp_eq_u32 s46, 14
    s_cbranch_scc1 L_fin1
    s_branch L_top1
    .p2align 12
L_pro2:
L_p0_2:
    ds_read_b32 v28, v16
    s_waitcnt lgkmcnt(0)
    v_cmp_gt_u32 vcc, 1, v28
    s_cbranch_vccnz L_p0_2
    ds_read_b128 v[32:35], v2 offset:0
    ds_read_b128 v[36:39], v3 offset:1280
    ds_read_b128 v[40:43], v2 offset:2560
    ds_read_b128 v[44:47], v3 offset:3840
    ds_read_b128 v[48:51], v2 offset:5120
    ds_read_b128 v[52:55], v3 offset:6400
    ds_read_b128 v[56:59], v2 offset:7680
    ds_read_b128 v[60:63], v3 offset:8960
    ds_read_b128 v[64:67], v2 offset:10240
    ds_read_b128 v[68:71], v3 offset:11520
    ds_read_b128 v[72:75], v2 offset:12800
L_p1_2:
    ds_read_b32 v28, v17
    s_waitcnt lgkmcnt(0)
    v_cmp_gt_u32 vcc, 1, v28
    s_cbranch_vccnz L_p1_2
    ds_read_b64_tr_b16 v[76:77], v4 offset:0
    ds_read_b64_tr_b16 v[78:79], v4 offset:768
    ds_read_b64_tr_b16 v[88:89], v4 offset:6144
    ds_read_b64_tr_b16 v[90:91], v4 offset:6912
    ds_read_b64_tr_b16 v[100:101], v4 offset:12288
    ds_read_b64_tr_b16 v[102:103], v4 offset:13056
    ds_read_b64_tr_b16 v[112:113], v4 offset:18432
    ds_read_b64_tr_b16 v[114:115], v4 offset:19200
    ds_read_b64_tr_b16 v[124:125], v4 offset:24576
    ds_read_b64_tr_b16 v[126:127], v4 offset:25344
    ds_read_b64_tr_b16 v[80:81], v5 offset:0
    ds_read_b64_tr_b16 v[82:83], v5 offset:768
    ds_read_b64_tr_b16 v[92:93], v5 offset:6144
    ds_read_b64_tr_b16 v[94:95], v5 offset:6912
    ds_read_b64_tr_b16 v[104:105], v5 offset:12288
    ds_read_b64_tr_b16 v[106:107], v5 offset:13056
    ds_read_b64_tr_b16 v[116:117], v5 offset:18432
    ds_read_b64_tr_b16 v[118:119], v5 offset:19200
    ds_read_b64_tr_b16 v[128:129], v5 offset:24576
    ds_read_b64_tr_b16 v[130:131], v5 offset:25344
    s_waitcnt lgkmcnt(14)
    s_branch L_head2
    .p2align 6
L_pad2:
    s_branch L_compute
    s_nop 0
L_top2:
    ds_read_b64_tr_b16 v[76:77], v4 offset:0
    v_mfma_f32_16x16x32_bf16 v[212:215], v[92:95], v[60:63], v[212:215]
    ds_read_b64_tr_b16 v[78:79], v4 offset:768
    v_mfma_f32_16x16x32_bf16 v[212:215], v[80:83], v[56:59], v[212:215]
    ds_read_b128 v[32:35], v2 offset:0
    v_mfma_f32_16x16x32_bf16 v[156:159], v[84:87], v[36:39], v[156:159]
    ds_read_b64_tr_b16 v[88:89], v4 offset:6144
    v_mfma_f32_16x16x32_bf16 v[156:159], v[96:99], v[40:43], v[156:159]
    ds_read_b64_tr_b16 v[90:91], v4 offset:6912
    v_mfma_f32_16x16x32_bf16 v[156:159], v[108:111], v[44:47], v[156:159]
    ds_read_b128 v[36:39], v3 offset:1280
    v_mfma_f32_16x16x32_bf16 v[156:159], v[120:123], v[48:51], v[156:159]
    ds_read_b64_tr_b16 v[100:101], v4 offset:12288
    v_mfma_f32_16x16x32_bf16 v[156:159], v[132:135], v[52:55], v[156:159]
    ds_read_b64_tr_b16 v[102:103], v4 offset:13056
    v_mfma_f32_16x16x32_bf16 v[168:171], v[132:135], v[56:59], v[168:171]
    ds_read_b64_tr_b16 v[112:113], v4 offset:18432
    v_mfma_f32_16x16x32_bf16 v[168:171], v[120:123], v[52:55], v[168:171]
    ds_read_b64_tr_b16 v[114:115], v4 offset:19200
    v_mfma_f32_16x16x32_bf16 v[168:171], v[108:111], v[48:51], v[168:171]
    ds_read_b64_tr_b16 v[124:125], v4 offset:24576
    v_mfma_f32_16x16x32_bf16 v[168:171], v[96:99], v[44:47], v[168:171]
    ds_read_b64_tr_b16 v[126:127], v4 offset:25344
    v_mfma_f32_16x16x32_bf16 v[168:171], v[84:87], v[40:43], v[168:171]
    ds_read_b128 v[40:43], v2 offset:2560
    v_mfma_f32_16x16x32_bf16 v[180:183], v[84:87], v[44:47], v[180:183]
    ds_read_b128 v[44:47], v3 offset:3840
    v_mfma_f32_16x16x32_bf16 v[180:183], v[96:99], v[48:51], v[180:183]
    ds_read_b64_tr_b16 v[80:81], v5 offset:0
    v_mfma_f32_16x16x32_bf16 v[180:183], v[108:111], v[52:55], v[180:183]
    ds_read_b64_tr_b16 v[82:83], v5 offset:768
    v_mfma_f32_16x16x32_bf16 v[180:183], v[120:123], v[56:59], v[180:183]
    ds_read_b64_tr_b16 v[92:93], v5 offset:6144
    v_mfma_f32_16x16x32_bf16 v[180:183], v[132:135], v[60:63], v[180:183]
    ds_read_b64_tr_b16 v[94:95], v5 offset:6912
    v_mfma_f32_16x16x32_bf16 v[192:195], v[132:135], v[64:67], v[192:195]
    ds_read_b64_tr_b16 v[104:105], v5 offset:12288
    v_mfma_f32_16x16x32_bf16 v[192:195], v[120:123], v[60:63], v[192:195]
    ds_read_b64_tr_b16 v[106:107], v5 offset:13056
    v_mfma_f32_16x16x32_bf16 v[192:195], v[108:111], v[56:59], v[192:195]
    ds_read_b64_tr_b16 v[116:117], v5 offset:18432
    v_mfma_f32_16x16x32_bf16 v[192:195], v[96:99], v[52:55], v[192:195]
    ds_read_b64_tr_b16 v[118:119], v5 offset:19200
    v_mfma_f32_16x16x32_bf16 v[192:195], v[84:87], v[48:51], v[192:195]
    ds_read_b128 v[48:51], v2 offset:5120
    v_mfma_f32_16x16x32_bf16 v[204:207], v[84:87], v[52:55], v[204:207]
    ds_read_b128 v[52:55], v3 offset:6400
    v_mfma_f32_16x16x32_bf16 v[204:207], v[96:99], v[56:59], v[204:207]
    ds_read_b64_tr_b16 v[128:129], v5 offset:24576
    s_add_u32 s46, s46, 1
    v_mfma_f32_16x16x32_bf16 v[204:207], v[108:111], v[60:63], v[204:207]
    ds_read_b64_tr_b16 v[130:131], v5 offset:25344
    v_mfma_f32_16x16x32_bf16 v[204:207], v[120:123], v[64:67], v[204:207]
    v_mfma_f32_16x16x32_bf16 v[204:207], v[132:135], v[68:71], v[204:207]
    v_mfma_f32_16x16x32_bf16 v[216:219], v[132:135], v[72:75], v[216:219]
    ds_read_b128 v[72:75], v2 offset:12800
    v_mfma_f32_16x16x32_bf16 v[216:219], v[120:123], v[68:71], v[216:219]
    ds_read_b128 v[68:71], v3 offset:11520
    v_mfma_f32_16x16x32_bf16 v[216:219], v[108:111], v[64:67], v[216:219]
    ds_read_b128 v[64:67], v2 offset:10240
    v_mfma_f32_16x16x32_bf16 v[216:219], v[96:99], v[60:63], v[216:219]
    ds_read_b128 v[60:63], v3 offset:8960
    v_mfma_f32_16x16x32_bf16 v[216:219], v[84:87], v[56:59], v[216:219]
    ds_read_b128 v[56:59], v2 offset:7680
L_head2:
    s_waitcnt lgkmcnt(6)
    v_mfma_f32_16x16x32_bf16 v[136:139], v[76:79], v[32:35], v[136:139]
    ds_read_b64_tr_b16 v[84:85], v6 offset:0
    v_mfma_f32_16x16x32_bf16 v[136:139], v[88:91], v[36:39], v[136:139]
    ds_read_b64_tr_b16 v[86:87], v6 offset:768
    v_mfma_f32_16x16x32_bf16 v[136:139], v[100:103], v[40:43], v[136:139]
    ds_read_b64_tr_b16 v[96:97], v6 offset:6144
    v_mfma_f32_16x16x32_bf16 v[136:139], v[112:115], v[44:47], v[136:139]
    ds_read_b64_tr_b16 v[98:99], v6 offset:6912
    v_mfma_f32_16x16x32_bf16 v[136:139], v[124:127], v[48:51], v[136:139]
    ds_read_b64_tr_b16 v[108:109], v6 offset:12288
    v_mfma_f32_16x16x32_bf16 v[148:151], v[124:127], v[52:55], v[148:151]
    ds_read_b64_tr_b16 v[110:111], v6 offset:13056
    v_mfma_f32_16x16x32_bf16 v[148:151], v[112:115], v[48:51], v[148:151]
    ds_read_b64_tr_b16 v[120:121], v6 offset:18432
    v_mfma_f32_16x16x32_bf16 v[148:151], v[100:103], v[44:47], v[148:151]
    ds_read_b64_tr_b16 v[122:123], v6 offset:19200
    v_mfma_f32_16x16x32_bf16 v[148:151], v[88:91], v[40:43], v[148:151]
    ds_read_b64_tr_b16 v[132:133], v6 offset:24576
    v_mfma_f32_16x16x32_bf16 v[148:151], v[76:79], v[36:39], v[148:151]
    v_add_u32 v27, 1, v27
    ds_read_b64_tr_b16 v[134:135], v6 offset:25344
    v_mfma_f32_16x16x32_bf16 v[160:163], v[76:79], v[40:43], v[160:163]
    ds_write_b32 v25, v27
    v_mfma_f32_16x16x32_bf16 v[160:163], v[88:91], v[44:47], v[160:163]
    v_mfma_f32_16x16x32_bf16 v[160:163], v[100:103], v[48:51], v[160:163]
    s_bitcmp1_b32 s40, s46
    v_mfma_f32_16x16x32_bf16 v[160:163], v[112:115], v[52:55], v[160:163]
    s_cselect_b32 s42, 22272, 64
    s_waitcnt lgkmcnt(5)
    v_mfma_f32_16x16x32_bf16 v[160:163], v[124:127], v[56:59], v[160:163]
    s_bitcmp1_b32 s41, s46
    v_mfma_f32_16x16x32_bf16 v[172:175], v[124:127], v[60:63], v[172:175]
    s_cselect_b32 s43, s44, s45
    v_mfma_f32_16x16x32_bf16 v[172:175], v[112:115], v[56:59], v[172:175]
    s_cmp_eq_u32 s46, 14
    v_mfma_f32_16x16x32_bf16 v[172:175], v[100:103], v[52:55], v[172:175]
    s_cselect_b32 s49, 1000, s46
    v_mfma_f32_16x16x32_bf16 v[172:175], v[88:91], v[48:51], v[172:175]
    v_add_u32 v1, s42, v1
    v_mfma_f32_16x16x32_bf16 v[172:175], v[76:79], v[44:47], v[172:175]
    v_lshrrev_b32 v11, 3, v1
    v_mfma_f32_16x16x32_bf16 v[184:187], v[76:79], v[48:51], v[184:187]
    v_and_b32 v11, 32, v11
    v_mfma_f32_16x16x32_bf16 v[184:187], v[88:91], v[52:55], v[184:187]
    v_xor_b32 v2, v1, v11
    v_mfma_f32_16x16x32_bf16 v[184:187], v[100:103], v[56:59], v[184:187]
    v_xor_b32 v3, 32, v2
    v_mfma_f32_16x16x32_bf16 v[184:187], v[112:115], v[60:63], v[184:187]
    v_add_u32 v4, s43, v4
    v_mfma_f32_16x16x32_bf16 v[184:187], v[124:127], v[64:67], v[184:187]
    v_add_u32 v5, s43, v5
    v_mfma_f32_16x16x32_bf16 v[196:199], v[124:127], v[68:71], v[196:199]
    v_add_u32 v6, s43, v6
    v_mfma_f32_16x16x32_bf16 v[196:199], v[112:115], v[64:67], v[196:199]
    v_mfma_f32_16x16x32_bf16 v[196:199], v[100:103], v[60:63], v[196:199]
    v_mfma_f32_16x16x32_bf16 v[196:199], v[88:91], v[56:59], v[196:199]
    v_mfma_f32_16x16x32_bf16 v[196:199], v[76:79], v[52:55], v[196:199]
    v_mfma_f32_16x16x32_bf16 v[208:211], v[76:79], v[56:59], v[208:211]
    v_mfma_f32_16x16x32_bf16 v[208:211], v[88:91], v[60:63], v[208:211]
    v_mfma_f32_16x16x32_bf16 v[208:211], v[100:103], v[64:67], v[208:211]
    v_mfma_f32_16x16x32_bf16 v[208:211], v[112:115], v[68:71], v[208:211]
    v_mfma_f32_16x16x32_bf16 v[208:211], v[124:127], v[72:75], v[208:211]
    v_mfma_f32_16x16x32_bf16 v[152:155], v[80:83], v[36:39], v[152:155]
    v_mfma_f32_16x16x32_bf16 v[152:155], v[92:95], v[40:43], v[152:155]
    v_mfma_f32_16x16x32_bf16 v[152:155], v[104:107], v[44:47], v[152:155]
    v_mfma_f32_16x16x32_bf16 v[152:155], v[116:119], v[48:51], v[152:155]
    v_mfma_f32_16x16x32_bf16 v[152:155], v[128:131], v[52:55], v[152:155]
    v_mfma_f32_16x16x32_bf16 v[164:167], v[128:131], v[56:59], v[164:167]
    v_mfma_f32_16x16x32_bf16 v[164:167], v[116:119], v[52:55], v[164:167]
    v_mfma_f32_16x16x32_bf16 v[164:167], v[104:107], v[48:51], v[164:167]
    v_mfma_f32_16x16x32_bf16 v[164:167], v[92:95], v[44:47], v[164:167]
    v_mfma_f32_16x16x32_bf16 v[164:167], v[80:83], v[40:43], v[164:167]
    v_mfma_f32_16x16x32_bf16 v[176:179], v[80:83], v[44:47], v[176:179]
    v_mfma_f32_16x16x32_bf16 v[176:179], v[92:95], v[48:51], v[176:179]
    v_mfma_f32_16x16x32_bf16 v[176:179], v[104:107], v[52:55], v[176:179]
    v_mfma_f32_16x16x32_bf16 v[176:179], v[116:119], v[56:59], v[176:179]
    v_mfma_f32_16x16x32_bf16 v[176:179], v[128:131], v[60:63], v[176:179]
    ds_read_b32 v28, v26
    v_mfma_f32_16x16x32_bf16 v[188:191], v[128:131], v[64:67], v[188:191]
    v_mfma_f32_16x16x32_bf16 v[188:191], v[116:119], v[60:63], v[188:191]
    v_mfma_f32_16x16x32_bf16 v[188:191], v[104:107], v[56:59], v[188:191]
    v_mfma_f32_16x16x32_bf16 v[188:191], v[92:95], v[52:55], v[188:191]
    v_mfma_f32_16x16x32_bf16 v[188:191], v[80:83], v[48:51], v[188:191]
    v_mfma_f32_16x16x32_bf16 v[200:203], v[80:83], v[52:55], v[200:203]
    v_mfma_f32_16x16x32_bf16 v[200:203], v[92:95], v[56:59], v[200:203]
    v_mfma_f32_16x16x32_bf16 v[200:203], v[104:107], v[60:63], v[200:203]
    s_waitcnt lgkmcnt(0)
    v_mfma_f32_16x16x32_bf16 v[200:203], v[116:119], v[64:67], v[200:203]
    v_cmp_gt_u32 vcc, s49, v28
    v_mfma_f32_16x16x32_bf16 v[200:203], v[128:131], v[68:71], v[200:203]
    v_mfma_f32_16x16x32_bf16 v[212:215], v[128:131], v[72:75], v[212:215]
    v_mfma_f32_16x16x32_bf16 v[212:215], v[116:119], v[68:71], v[212:215]
    v_mfma_f32_16x16x32_bf16 v[212:215], v[104:107], v[64:67], v[212:215]
    s_cbranch_vccz L_top2
    s_min_u32 s49, s49, 15
    v_cmp_gt_u32 vcc, s49, v28
    s_cbranch_vccz L_fin2
L_slow2:
    ds_read_b32 v28, v26
    s_waitcnt lgkmcnt(0)
    v_cmp_gt_u32 vcc, s49, v28
    s_cbranch_vccnz L_slow2
    s_cmp_eq_u32 s46, 14
    s_cbranch_scc1 L_fin2
    s_branch L_top2
L_pro3:
L_p0_3:
    ds_read_b32 v28, v16
    s_waitcnt lgkmcnt(0)
    v_cmp_gt_u32 vcc, 1, v28
    s_cbranch_vccnz L_p0_3
    ds_read_b128 v[32:35], v2 offset:0
    ds_read_b128 v[36:39], v3 offset:1280
    ds_read_b128 v[40:43], v2 offset:2560
    ds_read_b128 v[44:47], v3 offset:3840
    ds_read_b128 v[48:51], v2 offset:5120
    ds_read_b128 v[52:55], v3 offset:6400
    ds_read_b128 v[56:59], v2 offset:7680
    ds_read_b128 v[60:63], v3 offset:8960
    ds_read_b128 v[64:67], v2 offset:10240
    ds_read_b128 v[68:71], v3 offset:11520
L_p1_3:
    ds_read_b32 v28, v17
    s_waitcnt lgkmcnt(0)
    v_cmp_gt_u32 vcc, 1, v28
    s_cbranch_vccnz L_p1_3
    ds_read_b64_tr_b16 v[76:77], v4 offset:0
    ds_read_b64_tr_b16 v[78:79], v4 offset:768
    ds_read_b64_tr_b16 v[88:89], v4 offset:6144
    ds_read_b64_tr_b16 v[90:91], v4 offset:6912
    ds_read_b64_tr_b16 v[100:101], v4 offset:12288
    ds_read_b64_tr_b16 v[102:103], v4 offset:13056
    ds_read_b64_tr_b16 v[112:113], v4 offset:18432
    ds_read_b64_tr_b16 v[114:115], v4 offset:19200
    ds_read_b64_tr_b16 v[124:125], v4 offset:24576
    ds_read_b64_tr_b16 v[126:127], v4 offset:25344
    ds_read_b64_tr_b16 v[80:81], v5 offset:0
    ds_read_b64_tr_b16 v[82:83], v5 offset:768
    ds_read_b64_tr_b16 v[92:93], v5 offset:6144
    ds_read_b64_tr_b16 v[94:95], v5 offset:6912
    ds_read_b64_tr_b16 v[104:105], v5 offset:12288
    ds_read_b64_tr_b16 v[106:107], v5 offset:13056
    ds_read_b64_tr_b16 v[116:117], v5 offset:18432
    ds_read_b64_tr_b16 v[118:119], v5 offset:19200
    ds_read_b64_tr_b16 v[128:129], v5 offset:24576
    ds_read_b64_tr_b16 v[130:131], v5 offset:25344
    s_waitcnt lgkmcnt(14)
    s_branch L_head3
    .p2align 6
L_pad3:
    s_branch L_compute
    s_nop 0
L_top3:
    ds_read_b64_tr_b16 v[76:77], v4 offset:0
    v_mfma_f32_16x16x32_bf16 v[144:147], v[132:135], v[48:51], v[144:147]
    ds_read_b64_tr_b16 v[78:79], v4 offset:768
    v_mfma_f32_16x16x32_bf16 v[144:147], v[120:123], v[44:47], v[144:147]
    ds_read_b64_tr_b16 v[88:89], v4 offset:6144
    v_mfma_f32_16x16x32_bf16 v[144:147], v[108:111], v[40:43], v[144:147]
    ds_read_b64_tr_b16 v[90:91], v4 offset:6912
    v_mfma_f32_16x16x32_bf16 v[144:147], v[96:99], v[36:39], v[144:147]
    ds_read_b64_tr_b16 v[100:101], v4 offset:12288
    v_mfma_f32_16x16x32_bf16 v[144:147], v[84:87], v[32:35], v[144:147]
    ds_read_b128 v[32:35], v2 offset:0
    v_mfma_f32_16x16x32_bf16 v[156:159], v[84:87], v[36:39], v[156:159]
    ds_read_b128 v[36:39], v3 offset:1280
    v_mfma_f32_16x16x32_bf16 v[156:159], v[96:99], v[40:43], v[156:159]
    ds_read_b64_tr_b16 v[102:103], v4 offset:13056
    v_mfma_f32_16x16x32_bf16 v[156:159], v[108:111], v[44:47], v[156:159]
    ds_read_b64_tr_b16 v[112:113], v4 offset:18432
    v_mfma_f32_16x16x32_bf16 v[156:159], v[120:123], v[48:51], v[156:159]
    ds_read_b64_tr_b16 v[114:115], v4 offset:19200
    v_mfma_f32_16x16x32_bf16 v[156:159], v[132:135], v[52:55], v[156:159]
    ds_read_b64_tr_b16 v[124:125], v4 offset:24576
    v_mfma_f32_16x16x32_bf16 v[168:171], v[132:135], v[56:59], v[168:171]
    ds_read_b64_tr_b16 v[126:127], v4 offset:25344
    v_mfma_f32_16x16x32_bf16 v[168:171], v[120:123], v[52:55], v[168:171]
    ds_read_b64_tr_b16 v[80:81], v5 offset:0
    v_mfma_f32_16x16x32_bf16 v[168:171], v[108:111], v[48:51], v[168:171]
    ds_read_b64_tr_b16 v[82:83], v5 offset:768
    v_mfma_f32_16x16x32_bf16 v[168:171], v[96:99], v[44:47], v[168:171]
    ds_read_b64_tr_b16 v[92:93], v5 offset:6144
    v_mfma_f32_16x16x32_bf16 v[168:171], v[84:87], v[40:43], v[168:171]
    ds_read_b128 v[40:43], v2 offset:2560
    v_mfma_f32_16x16x32_bf16 v[180:183], v[84:87], v[44:47], v[180:183]
    ds_read_b128 v[44:47], v3 offset:3840
    v_mfma_f32_16x16x32_bf16 v[180:183], v[96:99], v[48:51], v[180:183]
    ds_read_b64_tr_b16 v[94:95], v5 offset:6912
    v_mfma_f32_16x16x32_bf16 v[180:183], v[108:111], v[52:55], v[180:183]
    ds_read_b64_tr_b16 v[104:105], v5 offset:12288
    v_mfma_f32_16x16x32_bf16 v[180:183], v[120:123], v[56:59], v[180:183]
    ds_read_b64_tr_b16 v[106:107], v5 offset:13056
    v_mfma_f32_16x16x32_bf16 v[180:183], v[132:135], v[60:63], v[180:183]
    ds_read_b64_tr_b16 v[116:117], v5 offset:18432
    v_mfma_f32_16x16x32_bf16 v[192:195], v[132:135], v[64:67], v[192:195]
    ds_read_b64_tr_b16 v[118:119], v5 offset:19200
    v_mfma_f32_16x16x32_bf16 v[192:195], v[120:123], v[60:63], v[192:195]
    ds_read_b64_tr_b16 v[128:129], v5 offset:24576
    s_add_u32 s46, s46, 1
    v_mfma_f32_16x16x32_bf16 v[192:195], v[108:111], v[56:59], v[192:195]
    ds_read_b64_tr_b16 v[130:131], v5 offset:25344
    v_mfma_f32_16x16x32_bf16 v[192:195], v[96:99], v[52:55], v[192:195]
    v_mfma_f32_16x16x32_bf16 v[192:195], v[84:87], v[48:51], v[192:195]
    ds_read_b128 v[48:51], v2 offset:5120
    v_mfma_f32_16x16x32_bf16 v[204:207], v[84:87], v[52:55], v[204:207]
    ds_read_b128 v[52:55], v3 offset:6400
    v_mfma_f32_16x16x32_bf16 v[204:207], v[96:99], v[56:59], v[204:207]
    ds_read_b128 v[56:59], v2 offset:7680
    v_mfma_f32_16x16x32_bf16 v[204:207], v[108:111], v[60:63], v[204:207]
    ds_read_b128 v[60:63], v3 offset:8960
    v_mfma_f32_16x16x32_bf16 v[204:207], v[120:123], v[64:67], v[204:207]
    ds_read_b128 v[64:67], v2 offset:10240
    v_mfma_f32_16x16x32_bf16 v[204:207], v[132:135], v[68:71], v[204:207]
    ds_read_b128 v[68:71], v3 offset:11520
L_head3:
    s_waitcnt lgkmcnt(7)
    v_mfma_f32_16x16x32_bf16 v[136:139], v[76:79], v[32:35], v[136:139]
    ds_read_b64_tr_b16 v[132:133], v6 offset:24576
    v_mfma_f32_16x16x32_bf16 v[136:139], v[88:91], v[36:39], v[136:139]
    ds_read_b64_tr_b16 v[134:135], v6 offset:25344
    v_mfma_f32_16x16x32_bf16 v[136:139], v[100:103], v[40:43], v[136:139]
    ds_read_b64_tr_b16 v[120:121], v6 offset:18432
    v_mfma_f32_16x16x32_bf16 v[136:139], v[112:115], v[44:47], v[136:139]
    ds_read_b64_tr_b16 v[122:123], v6 offset:19200
    s_waitcnt lgkmcnt(8)
    v_mfma_f32_16x16x32_bf16 v[136:139], v[124:127], v[48:51], v[136:139]
    ds_read_b64_tr_b16 v[108:109], v6 offset:12288
    v_mfma_f32_16x16x32_bf16 v[148:151], v[124:127], v[52:55], v[148:151]
    ds_read_b64_tr_b16 v[110:111], v6 offset:13056
    v_mfma_f32_16x16x32_bf16 v[148:151], v[112:115], v[48:51], v[148:151]
    ds_read_b64_tr_b16 v[96:97], v6 offset:6144
    v_mfma_f32_16x16x32_bf16 v[148:151], v[100:103], v[44:47], v[148:151]
    ds_read_b64_tr_b16 v[98:99], v6 offset:6912
    v_mfma_f32_16x16x32_bf16 v[148:151], v[88:91], v[40:43], v[148:151]
    ds_read_b64_tr_b16 v[84:85], v6 offset:0
    v_mfma_f32_16x16x32_bf16 v[148:151], v[76:79], v[36:39], v[148:151]
    v_add_u32 v27, 1, v27
    ds_read_b64_tr_b16 v[86:87], v6 offset:768
    v_mfma_f32_16x16x32_bf16 v[160:163], v[76:79], v[40:43], v[160:163]
    ds_write_b32 v25, v27
    v_mfma_f32_16x16x32_bf16 v[160:163], v[88:91], v[44:47], v[160:163]
    v_mfma_f32_16x16x32_bf16 v[160:163], v[100:103], v[48:51], v[160:163]
    s_bitcmp1_b32 s40, s46
    v_mfma_f32_16x16x32_bf16 v[160:163], v[112:115], v[52:55], v[160:163]
    s_cselect_b32 s42, 22272, 64
    s_waitcnt lgkmcnt(5)
    v_mfma_f32_16x16x32_bf16 v[160:163], v[124:127], v[56:59], v[160:163]
    s_bitcmp1_b32 s41, s46
    v_mfma_f32_16x16x32_bf16 v[172:175], v[124:127], v[60:63], v[172:175]
    s_cselect_b32 s43, s44, s45
    v_mfma_f32_16x16x32_bf16 v[172:175], v[112:115], v[56:59], v[172:175]
    s_cmp_eq_u32 s46, 14
    v_mfma_f32_16x16x32_bf16 v[172:175], v[100:103], v[52:55], v[172:175]
    s_cselect_b32 s49, 1000, s46
    v_mfma_f32_16x16x32_bf16 v[172:175], v[88:91], v[48:51], v[172:175]
    v_add_u32 v1, s42, v1
    v_mfma_f32_16x16x32_bf16 v[172:175], v[76:79], v[44:47], v[172:175]
    v_lshrrev_b32 v11, 3, v1
    v_mfma_f32_16x16x32_bf16 v[184:187], v[76:79], v[48:51], v[184:187]
    v_and_b32 v11, 32, v11
    v_mfma_f32_16x16x32_bf16 v[184:187], v[88:91], v[52:55], v[184:187]
    v_xor_b32 v2, v1, v11
    v_mfma_f32_16x16x32_bf16 v[184:187], v[100:103], v[56:59], v[184:187]
    v_xor_b32 v3, 32, v2
    v_mfma_f32_16x16x32_bf16 v[184:187], v[112:115], v[60:63], v[184:187]
    v_add_u32 v4, s43, v4
    v_mfma_f32_16x16x32_bf16 v[184:187], v[124:127], v[64:67], v[184:187]
    v_add_u32 v5, s43, v5
    v_mfma_f32_16x16x32_bf16 v[196:199], v[124:127], v[68:71], v[196:199]
    v_add_u32 v6, s43, v6
    v_mfma_f32_16x16x32_bf16 v[196:199], v[112:115], v[64:67], v[196:199]
    v_mfma_f32_16x16x32_bf16 v[196:199], v[100:103], v[60:63], v[196:199]
    v_mfma_f32_16x16x32_bf16 v[196:199], v[88:91], v[56:59], v[196:199]
    v_mfma_f32_16x16x32_bf16 v[196:199], v[76:79], v[52:55], v[196:199]
    v_mfma_f32_16x16x32_bf16 v[140:143], v[80:83], v[32:35], v[140:143]
    v_mfma_f32_16x16x32_bf16 v[140:143], v[92:95], v[36:39], v[140:143]
    v_mfma_f32_16x16x32_bf16 v[140:143], v[104:107], v[40:43], v[140:143]
    v_mfma_f32_16x16x32_bf16 v[140:143], v[116:119], v[44:47], v[140:143]
    v_mfma_f32_16x16x32_bf16 v[140:143], v[128:131], v[48:51], v[140:143]
    v_mfma_f32_16x16x32_bf16 v[152:155], v[128:131], v[52:55], v[152:155]
    v_mfma_f32_16x16x32_bf16 v[152:155], v[116:119], v[48:51], v[152:155]
    v_mfma_f32_16x16x32_bf16 v[152:155], v[104:107], v[44:47], v[152:155]
    v_mfma_f32_16x16x32_bf16 v[152:155], v[92:95], v[40:43], v[152:155]
    v_mfma_f32_16x16x32_bf16 v[152:155], v[80:83], v[36:39], v[152:155]
    v_mfma_f32_16x16x32_bf16 v[164:167], v[80:83], v[40:43], v[164:167]
    v_mfma_f32_16x16x32_bf16 v[164:167], v[92:95], v[44:47], v[164:167]
    v_mfma_f32_16x16x32_bf16 v[164:167], v[104:107], v[48:51], v[164:167]
    v_mfma_f32_16x16x32_bf16 v[164:167], v[116:119], v[52:55], v[164:167]
    v_mfma_f32_16x16x32_bf16 v[164:167], v[128:131], v[56:59], v[164:167]
    v_mfma_f32_16x16x32_bf16 v[176:179], v[128:131], v[60:63], v[176:179]
    v_mfma_f32_16x16x32_bf16 v[176:179], v[116:119], v[56:59], v[176:179]
    ds_read_b32 v28, v26
    v_mfma_f32_16x16x32_bf16 v[176:179], v[104:107], v[52:55], v[176:179]
    v_mfma_f32_16x16x32_bf16 v[176:179], v[92:95], v[48:51], v[176:179]
    v_mfma_f32_16x16x32_bf16 v[176:179], v[80:83], v[44:47], v[176:179]
    v_mfma_f32_16x16x32_bf16 v[188:191], v[80:83], v[48:51], v[188:191]
    v_mfma_f32_16x16x32_bf16 v[188:191], v[92:95], v[52:55], v[188:191]
    v_mfma_f32_16x16x32_bf16 v[188:191], v[104:107], v[56:59], v[188:191]
    v_mfma_f32_16x16x32_bf16 v[188:191], v[116:119], v[60:63], v[188:191]
    v_mfma_f32_16x16x32_bf16 v[188:191], v[128:131], v[64:67], v[188:191]
    s_waitcnt lgkmcnt(0)
    v_mfma_f32_16x16x32_bf16 v[200:203], v[128:131], v[68:71], v[200:203]
    v_cmp_gt_u32 vcc, s49, v28
    v_mfma_f32_16x16x32_bf16 v[200:203], v[116:119], v[64:67], v[200:203]
    v_mfma_f32_16x16x32_bf16 v[200:203], v[104:107], v[60:63], v[200:203]
    v_mfma_f32_16x16x32_bf16 v[200:203], v[92:95], v[56:59], v[200:203]
    v_mfma_f32_16x16x32_bf16 v[200:203], v[80:83], v[52:55], v[200:203]
    s_cbranch_vccz L_top3
    s_min_u32 s49, s49, 15
    v_cmp_gt_u32 vcc, s49, v28
    s_cbranch_vccz L_fin3
L_slow3:
    ds_read_b32 v28, v26
    s_waitcnt lgkmcnt(0)
    v_cmp_gt_u32 vcc, s49, v28
    s_cbranch_vccnz L_slow3
    s_cmp_eq_u32 s46, 14
    s_cbranch_scc1 L_fin3
    s_branch L_top3
    .p2align 12
L_padf0:
    s_branch L_store2
    s_nop 0
L_fin0:
    ds_read_b64_tr_b16 v[76:77], v4 offset:0
    v_mfma_f32_16x16x32_bf16 v[212:215], v[116:119], v[68:71], v[212:215]
    ds_read_b64_tr_b16 v[78:79], v4 offset:768
    v_mfma_f32_16x16x32_bf16 v[212:215], v[128:131], v[72:75], v[212:215]
    ds_read_b64_tr_b16 v[88:89], v4 offset:6144
    v_mfma_f32_16x16x32_bf16 v[144:147], v[132:135], v[48:51], v[144:147]
    ds_read_b64_tr_b16 v[90:91], v4 offset:6912
    v_mfma_f32_16x16x32_bf16 v[144:147], v[120:123], v[44:47], v[144:147]
    ds_read_b64_tr_b16 v[100:101], v4 offset:12288
    v_mfma_f32_16x16x32_bf16 v[144:147], v[108:111], v[40:43], v[144:147]
    ds_read_b64_tr_b16 v[102:103], v4 offset:13056
    v_mfma_f32_16x16x32_bf16 v[144:147], v[96:99], v[36:39], v[144:147]
    ds_read_b64_tr_b16 v[112:113], v4 offset:18432
    v_mfma_f32_16x16x32_bf16 v[144:147], v[84:87], v[32:35], v[144:147]
    ds_read_b128 v[32:35], v2 offset:0
    v_mfma_f32_16x16x32_bf16 v[156:159], v[84:87], v[36:39], v[156:159]
    ds_read_b128 v[36:39], v3 offset:1280
    v_mfma_f32_16x16x32_bf16 v[156:159], v[96:99], v[40:43], v[156:159]
    ds_read_b64_tr_b16 v[114:115], v4 offset:19200
    v_mfma_f32_16x16x32_bf16 v[156:159], v[108:111], v[44:47], v[156:159]
    ds_read_b64_tr_b16 v[124:125], v4 offset:24576
    v_mfma_f32_16x16x32_bf16 v[156:159], v[120:123], v[48:51], v[156:159]
    ds_read_b64_tr_b16 v[126:127], v4 offset:25344
    v_mfma_f32_16x16x32_bf16 v[156:159], v[132:135], v[52:55], v[156:159]
    ds_read_b64_tr_b16 v[80:81], v5 offset:0
    v_mfma_f32_16x16x32_bf16 v[168:171], v[132:135], v[56:59], v[168:171]
    ds_read_b64_tr_b16 v[82:83], v5 offset:768
    v_mfma_f32_16x16x32_bf16 v[168:171], v[120:123], v[52:55], v[168:171]
    ds_read_b64_tr_b16 v[92:93], v5 offset:6144
    v_mfma_f32_16x16x32_bf16 v[168:171], v[108:111], v[48:51], v[168:171]
    ds_read_b64_tr_b16 v[94:95], v5 offset:6912
    v_mfma_f32_16x16x32_bf16 v[168:171], v[96:99], v[44:47], v[168:171]
    ds_read_b64_tr_b16 v[104:105], v5 offset:12288
    v_mfma_f32_16x16x32_bf16 v[168:171], v[84:87], v[40:43], v[168:171]
    ds_read_b128 v[40:43], v2 offset:2560
    v_mfma_f32_16x16x32_bf16 v[180:183], v[84:87], v[44:47], v[180:183]
    ds_read_b128 v[44:47], v3 offset:3840
    v_mfma_f32_16x16x32_bf16 v[180:183], v[96:99], v[48:51], v[180:183]
    ds_read_b64_tr_b16 v[106:107], v5 offset:13056
    v_mfma_f32_16x16x32_bf16 v[180:183], v[108:111], v[52:55], v[180:183]
    ds_read_b64_tr_b16 v[116:117], v5 offset:18432
    v_mfma_f32_16x16x32_bf16 v[180:183], v[120:123], v[56:59], v[180:183]
    ds_read_b64_tr_b16 v[118:119], v5 offset:19200
    v_mfma_f32_16x16x32_bf16 v[180:183], v[132:135], v[60:63], v[180:183]
    ds_read_b64_tr_b16 v[128:129], v5 offset:24576
    v_mfma_f32_16x16x32_bf16 v[192:195], v[132:135], v[64:67], v[192:195]
    ds_read_b64_tr_b16 v[130:131], v5 offset:25344
    v_mfma_f32_16x16x32_bf16 v[192:195], v[120:123], v[60:63], v[192:195]
    ds_read_b128 v[72:75], v2 offset:12800
    s_add_u32 s46, s46, 1
    v_mfma_f32_16x16x32_bf16 v[192:195], v[108:111], v[56:59], v[192:195]
    v_mfma_f32_16x16x32_bf16 v[192:195], v[96:99], v[52:55], v[192:195]
    v_mfma_f32_16x16x32_bf16 v[192:195], v[84:87], v[48:51], v[192:195]
    ds_read_b128 v[48:51], v2 offset:5120
    v_mfma_f32_16x16x32_bf16 v[204:207], v[84:87], v[52:55], v[204:207]
    ds_read_b128 v[52:55], v3 offset:6400
    v_mfma_f32_16x16x32_bf16 v[204:207], v[96:99], v[56:59], v[204:207]
    ds_read_b128 v[56:59], v2 offset:7680
    v_mfma_f32_16x16x32_bf16 v[204:207], v[108:111], v[60:63], v[204:207]
    ds_read_b128 v[60:63], v3 offset:8960
    v_mfma_f32_16x16x32_bf16 v[204:207], v[120:123], v[64:67], v[204:207]
    ds_read_b128 v[64:67], v2 offset:10240
    v_mfma_f32_16x16x32_bf16 v[204:207], v[132:135], v[68:71], v[204:207]
    ds_read_b128 v[68:71], v3 offset:11520
    s_waitcnt vmcnt(0)
    s_waitcnt lgkmcnt(6)
    v_mfma_f32_16x16x32_bf16 v[136:139], v[76:79], v[32:35], v[136:139]
    ds_read_b64_tr_b16 v[32:33], v4 offset:36864
    v_add_u32 v1, 64, v1
    v_mfma_f32_16x16x32_bf16 v[136:139], v[88:91], v[36:39], v[136:139]
    ds_read_b64_tr_b16 v[34:35], v4 offset:37632
    v_lshrrev_b32 v11, 3, v1
    v_mfma_f32_16x16x32_bf16 v[136:139], v[100:103], v[40:43], v[136:139]
    ds_read_b64_tr_b16 v[84:85], v4 offset:43008
    v_and_b32 v11, 32, v11
    v_mfma_f32_16x16x32_bf16 v[136:139], v[112:115], v[44:47], v[136:139]
    ds_read_b64_tr_b16 v[86:87], v4 offset:43776
    v_xor_b32 v22, v1, v11
    s_waitcnt lgkmcnt(8)
    v_mfma_f32_16x16x32_bf16 v[136:139], v[124:127], v[48:51], v[136:139]
    ds_read_b64_tr_b16 v[108:109], v4 offset:49152
    v_xor_b32 v23, 32, v22
    v_mfma_f32_16x16x32_bf16 v[148:151], v[124:127], v[52:55], v[148:151]
    ds_read_b64_tr_b16 v[110:111], v4 offset:49920
    v_mfma_f32_16x16x32_bf16 v[148:151], v[112:115], v[48:51], v[148:151]
    ds_read_b128 v[72:75], v23 offset:1280
    v_mfma_f32_16x16x32_bf16 v[148:151], v[100:103], v[44:47], v[148:151]
    ds_read_b128 v[96:99], v22 offset:2560
    v_mfma_f32_16x16x32_bf16 v[148:151], v[88:91], v[40:43], v[148:151]
    ds_read_b128 v[120:123], v23 offset:3840
    v_mfma_f32_16x16x32_bf16 v[148:151], v[76:79], v[36:39], v[148:151]
    ds_read_b128 v[36:39], v22 offset:0
    v_mfma_f32_16x16x32_bf16 v[160:163], v[76:79], v[40:43], v[160:163]
    ds_read_b64_tr_b16 v[40:41], v4 offset:30720
    v_mfma_f32_16x16x32_bf16 v[160:163], v[88:91], v[44:47], v[160:163]
    ds_read_b64_tr_b16 v[42:43], v4 offset:31488
    v_mfma_f32_16x16x32_bf16 v[160:163], v[100:103], v[48:51], v[160:163]
    ds_read_b64_tr_b16 v[132:133], v4 offset:55296
    v_mfma_f32_16x16x32_bf16 v[160:163], v[112:115], v[52:55], v[160:163]
    ds_read_b64_tr_b16 v[134:135], v4 offset:56064
    s_waitcnt lgkmcnt(8)
    v_mfma_f32_16x16x32_bf16 v[160:163], v[124:127], v[56:59], v[160:163]
    ds_read_b128 v[220:223], v22 offset:5120
    v_mfma_f32_16x16x32_bf16 v[172:175], v[124:127], v[60:63], v[172:175]
    ds_read_b128 v[224:227], v23 offset:6400
    v_mfma_f32_16x16x32_bf16 v[172:175], v[112:115], v[56:59], v[172:175]
    ds_read_b64_tr_b16 v[228:229], v6 offset:49152
    v_mfma_f32_16x16x32_bf16 v[172:175], v[100:103], v[52:55], v[172:175]
    ds_read_b64_tr_b16 v[230:231], v6 offset:49920
    v_mfma_f32_16x16x32_bf16 v[172:175], v[88:91], v[48:51], v[172:175]
    ds_read_b64_tr_b16 v[232:233], v6 offset:55296
    v_mfma_f32_16x16x32_bf16 v[172:175], v[76:79], v[44:47], v[172:175]
    ds_read_b64_tr_b16 v[44:45], v6 offset:43008
    v_mfma_f32_16x16x32_bf16 v[184:187], v[76:79], v[48:51], v[184:187]
    ds_read_b128 v[48:51], v22 offset:7680
    v_mfma_f32_16x16x32_bf16 v[184:187], v[88:91], v[52:55], v[184:187]
    ds_read_b64_tr_b16 v[46:47], v6 offset:43776
    v_mfma_f32_16x16x32_bf16 v[184:187], v[100:103], v[56:59], v[184:187]
    ds_read_b64_tr_b16 v[234:235], v6 offset:56064
    v_mfma_f32_16x16x32_bf16 v[184:187], v[112:115], v[60:63], v[184:187]
    ds_read_b128 v[236:239], v22 offset:5120
    v_mfma_f32_16x16x32_bf16 v[184:187], v[124:127], v[64:67], v[184:187]
    ds_read_b128 v[240:243], v2 offset:5120
    v_mfma_f32_16x16x32_bf16 v[196:199], v[124:127], v[68:71], v[196:199]
    ds_read_b128 v[68:71], v23 offset:8960
    v_mfma_f32_16x16x32_bf16 v[196:199], v[112:115], v[64:67], v[196:199]
    ds_read_b128 v[64:67], v3 offset:11520
    v_mfma_f32_16x16x32_bf16 v[196:199], v[100:103], v[60:63], v[196:199]
    ds_read_b64_tr_b16 v[60:61], v5 offset:30720
    v_mfma_f32_16x16x32_bf16 v[196:199], v[88:91], v[56:59], v[196:199]
    ds_read_b64_tr_b16 v[56:57], v5 offset:43008
    v_mfma_f32_16x16x32_bf16 v[196:199], v[76:79], v[52:55], v[196:199]
    ds_read_b128 v[52:55], v23 offset:11520
    s_waitcnt lgkmcnt(8)
    v_mfma_f32_16x16x32_bf16 v[136:139], v[40:43], v[36:39], v[136:139]
    ds_read_b128 v[36:39], v22 offset:10240
    v_mfma_f32_16x16x32_bf16 v[136:139], v[32:35], v[72:75], v[136:139]
    ds_read_b64_tr_b16 v[76:77], v5 offset:49152
    v_mfma_f32_16x16x32_bf16 v[136:139], v[84:87], v[96:99], v[136:139]
    ds_read_b64_tr_b16 v[78:79], v5 offset:49920
    v_mfma_f32_16x16x32_bf16 v[136:139], v[108:111], v[120:123], v[136:139]
    ds_read_b64_tr_b16 v[58:59], v5 offset:43776
    v_mfma_f32_16x16x32_bf16 v[136:139], v[132:135], v[220:223], v[136:139]
    ds_read_b64_tr_b16 v[88:89], v5 offset:36864
    v_mfma_f32_16x16x32_bf16 v[148:151], v[132:135], v[224:227], v[148:151]
    ds_read_b64_tr_b16 v[90:91], v5 offset:37632
    v_mfma_f32_16x16x32_bf16 v[148:151], v[108:111], v[220:223], v[148:151]
    ds_read_b64_tr_b16 v[62:63], v5 offset:31488
    v_mfma_f32_16x16x32_bf16 v[148:151], v[84:87], v[120:123], v[148:151]
    ds_read_b128 v[100:103], v2 offset:12800
    v_mfma_f32_16x16x32_bf16 v[148:151], v[32:35], v[96:99], v[148:151]
    ds_read_b128 v[112:115], v2 offset:10240
    v_mfma_f32_16x16x32_bf16 v[148:151], v[40:43], v[72:75], v[148:151]
    ds_read_b128 v[72:75], v22 offset:12800
    v_mfma_f32_16x16x32_bf16 v[160:163], v[40:43], v[96:99], v[160:163]
    ds_read_b64_tr_b16 v[96:97], v5 offset:55296
    v_mfma_f32_16x16x32_bf16 v[160:163], v[32:35], v[120:123], v[160:163]
    ds_read_b64_tr_b16 v[98:99], v5 offset:56064
    v_mfma_f32_16x16x32_bf16 v[160:163], v[84:87], v[220:223], v[160:163]
    ds_read_b128 v[124:127], v3 offset:8960
    v_mfma_f32_16x16x32_bf16 v[160:163], v[108:111], v[224:227], v[160:163]
    v_cvt_pk_bf16_f32 v136, v136, v137
    v_mfma_f32_16x16x32_bf16 v[160:163], v[132:135], v[48:51], v[160:163]
    v_cvt_pk_bf16_f32 v137, v138, v139
    s_waitcnt lgkmcnt(6)
    v_mfma_f32_16x16x32_bf16 v[172:175], v[132:135], v[68:71], v[172:175]
    v_mov_b32 v27, 16
    v_mfma_f32_16x16x32_bf16 v[172:175], v[108:111], v[48:51], v[172:175]
    ds_write_b64 v10, v[136:137] offset:0
    v_mfma_f32_16x16x32_bf16 v[172:175], v[84:87], v[224:227], v[172:175]
    ds_write_b32 v25, v27
    v_mfma_f32_16x16x32_bf16 v[172:175], v[32:35], v[220:223], v[172:175]
    v_cvt_pk_bf16_f32 v148, v148, v149
    v_mfma_f32_16x16x32_bf16 v[172:175], v[40:43], v[120:123], v[172:175]
    ds_read_b128 v[120:123], v2 offset:7680
    v_mfma_f32_16x16x32_bf16 v[184:187], v[40:43], v[220:223], v[184:187]
    ds_read_b64_tr_b16 v[220:221], v6 offset:36864
    v_mfma_f32_16x16x32_bf16 v[184:187], v[32:35], v[224:227], v[184:187]
    ds_read_b64_tr_b16 v[222:223], v6 offset:37632
    v_mfma_f32_16x16x32_bf16 v[184:187], v[84:87], v[48:51], v[184:187]
    v_cvt_pk_bf16_f32 v149, v150, v151
    v_mfma_f32_16x16x32_bf16 v[184:187], v[108:111], v[68:71], v[184:187]
    v_mov_b32 v27, 17
    v_mfma_f32_16x16x32_bf16 v[184:187], v[132:135], v[36:39], v[184:187]
    ds_write_b64 v10, v[148:149] offset:3328
    v_mfma_f32_16x16x32_bf16 v[196:199], v[132:135], v[52:55], v[196:199]
    ds_read_b64_tr_b16 v[132:133], v6 offset:24576
    v_mfma_f32_16x16x32_bf16 v[196:199], v[108:111], v[36:39], v[196:199]
    ds_read_b64_tr_b16 v[108:109], v6 offset:18432
    v_mfma_f32_16x16x32_bf16 v[196:199], v[84:87], v[68:71], v[196:199]
    ds_read_b64_tr_b16 v[84:85], v6 offset:12288
    v_mfma_f32_16x16x32_bf16 v[196:199], v[32:35], v[48:51], v[196:199]
    ds_read_b64_tr_b16 v[32:33], v6 offset:6144
    v_mfma_f32_16x16x32_bf16 v[196:199], v[40:43], v[224:227], v[196:199]
    ds_read_b128 v[40:43], v3 offset:6400
    s_waitcnt lgkmcnt(6)
    v_mfma_f32_16x16x32_bf16 v[212:215], v[96:99], v[72:75], v[212:215]
    ds_read_b64_tr_b16 v[72:73], v6 offset:0
    v_mfma_f32_16x16x32_bf16 v[212:215], v[76:79], v[52:55], v[212:215]
    ds_read_b64_tr_b16 v[74:75], v6 offset:768
    v_mfma_f32_16x16x32_bf16 v[212:215], v[56:59], v[36:39], v[212:215]
    ds_read_b64_tr_b16 v[34:35], v6 offset:6912
    v_mfma_f32_16x16x32_bf16 v[212:215], v[88:91], v[68:71], v[212:215]
    ds_read_b64_tr_b16 v[86:87], v6 offset:13056
    v_mfma_f32_16x16x32_bf16 v[212:215], v[60:63], v[48:51], v[212:215]
    ds_read_b64_tr_b16 v[110:111], v6 offset:19200
    v_mfma_f32_16x16x32_bf16 v[212:215], v[128:131], v[100:103], v[212:215]
    ds_read_b64_tr_b16 v[134:135], v6 offset:25344
    v_mfma_f32_16x16x32_bf16 v[212:215], v[116:119], v[64:67], v[212:215]
    ds_read_b64_tr_b16 v[100:101], v6 offset:30720
    v_mfma_f32_16x16x32_bf16 v[212:215], v[104:107], v[112:115], v[212:215]
    ds_read_b64_tr_b16 v[102:103], v6 offset:31488
    v_mfma_f32_16x16x32_bf16 v[212:215], v[92:95], v[124:127], v[212:215]
    ds_write_b32 v25, v27
    v_mfma_f32_16x16x32_bf16 v[212:215], v[80:83], v[120:123], v[212:215]
    v_cvt_pk_bf16_f32 v160, v160, v161
    v_mfma_f32_16x16x32_bf16 v[200:203], v[96:99], v[52:55], v[200:203]
    v_cvt_pk_bf16_f32 v161, v162, v163
    v_mfma_f32_16x16x32_bf16 v[200:203], v[76:79], v[36:39], v[200:203]
    v_mov_b32 v27, 18
    v_mfma_f32_16x16x32_bf16 v[200:203], v[56:59], v[68:71], v[200:203]
    ds_write_b64 v10, v[160:161] offset:6656
    v_mfma_f32_16x16x32_bf16 v[200:203], v[88:91], v[48:51], v[200:203]
    ds_write_b32 v25, v27
    v_mfma_f32_16x16x32_bf16 v[200:203], v[60:63], v[224:227], v[200:203]
    v_cvt_pk_bf16_f32 v172, v172, v173
    v_mfma_f32_16x16x32_bf16 v[200:203], v[128:131], v[64:67], v[200:203]
    v_cvt_pk_bf16_f32 v173, v174, v175
    v_mfma_f32_16x16x32_bf16 v[200:203], v[116:119], v[112:115], v[200:203]
    v_mov_b32 v27, 19
    v_mfma_f32_16x16x32_bf16 v[200:203], v[104:107], v[124:127], v[200:203]
    ds_write_b64 v10, v[172:173] offset:9984
    v_mfma_f32_16x16x32_bf16 v[200:203], v[92:95], v[120:123], v[200:203]
    ds_write_b32 v25, v27
    s_waitcnt lgkmcnt(4)
    v_mfma_f32_16x16x32_bf16 v[200:203], v[80:83], v[40:43], v[200:203]
    v_cvt_pk_bf16_f32 v184, v184, v185
    v_mfma_f32_16x16x32_bf16 v[204:207], v[72:75], v[40:43], v[204:207]
    v_cvt_pk_bf16_f32 v185, v186, v187
    v_mfma_f32_16x16x32_bf16 v[204:207], v[32:35], v[120:123], v[204:207]
    v_mov_b32 v27, 20
    v_mfma_f32_16x16x32_bf16 v[204:207], v[84:87], v[124:127], v[204:207]
    ds_write_b64 v10, v[184:185] offset:13312
    v_mfma_f32_16x16x32_bf16 v[204:207], v[108:111], v[112:115], v[204:207]
    ds_write_b32 v25, v27
    v_mfma_f32_16x16x32_bf16 v[204:207], v[132:135], v[64:67], v[204:207]
    ds_read_b128 v[64:67], v3 offset:3840
    v_mfma_f32_16x16x32_bf16 v[204:207], v[100:103], v[224:227], v[204:207]
    v_cvt_pk_bf16_f32 v196, v196, v197
    v_mfma_f32_16x16x32_bf16 v[204:207], v[220:223], v[48:51], v[204:207]
    v_cvt_pk_bf16_f32 v197, v198, v199
    v_mfma_f32_16x16x32_bf16 v[204:207], v[44:47], v[68:71], v[204:207]
    v_mov_b32 v27, 21
    v_mfma_f32_16x16x32_bf16 v[204:207], v[228:231], v[36:39], v[204:207]
    ds_write_b64 v10, v[196:197] offset:16640
    v_mfma_f32_16x16x32_bf16 v[204:207], v[232:235], v[52:55], v[204:207]
    ds_read_b128 v[52:55], v23 offset:3840
    v_mfma_f32_16x16x32_bf16 v[192:195], v[232:235], v[36:39], v[192:195]
    ds_write_b32 v25, v27
    v_mfma_f32_16x16x32_bf16 v[192:195], v[228:231], v[68:71], v[192:195]
    v_cvt_pk_bf16_f32 v212, v212, v213
    v_mfma_f32_16x16x32_bf16 v[192:195], v[44:47], v[48:51], v[192:195]
    v_cvt_pk_bf16_f32 v213, v214, v215
    v_mfma_f32_16x16x32_bf16 v[192:195], v[220:223], v[224:227], v[192:195]
    v_mov_b32 v27, 24
    v_mfma_f32_16x16x32_bf16 v[192:195], v[100:103], v[236:239], v[192:195]
    ds_write_b64 v9, v[212:213] offset:19968
    v_mfma_f32_16x16x32_bf16 v[192:195], v[132:135], v[112:115], v[192:195]
    ds_write_b32 v25, v27
    v_mfma_f32_16x16x32_bf16 v[192:195], v[108:111], v[124:127], v[192:195]
    v_cvt_pk_bf16_f32 v200, v200, v201
    v_mfma_f32_16x16x32_bf16 v[192:195], v[84:87], v[120:123], v[192:195]
    v_cvt_pk_bf16_f32 v201, v202, v203
    v_mfma_f32_16x16x32_bf16 v[192:195], v[32:35], v[40:43], v[192:195]
    ds_write_b64 v9, v[200:201] offset:16640
    v_mfma_f32_16x16x32_bf16 v[192:195], v[72:75], v[240:243], v[192:195]
    v_cvt_pk_bf16_f32 v204, v204, v205
    v_mfma_f32_16x16x32_bf16 v[188:191], v[80:83], v[240:243], v[188:191]
    v_cvt_pk_bf16_f32 v205, v206, v207
    v_mfma_f32_16x16x32_bf16 v[188:191], v[92:95], v[40:43], v[188:191]
    v_mov_b32 v27, 25
    v_mfma_f32_16x16x32_bf16 v[188:191], v[104:107], v[120:123], v[188:191]
    ds_write_b64 v9, v[204:205] offset:16672
    v_mfma_f32_16x16x32_bf16 v[188:191], v[116:119], v[124:127], v[188:191]
    ds_write_b32 v25, v27
    v_mfma_f32_16x16x32_bf16 v[188:191], v[128:131], v[112:115], v[188:191]
    ds_read_b128 v[112:115], v2 offset:2560
    v_mfma_f32_16x16x32_bf16 v[188:191], v[60:63], v[236:239], v[188:191]
    v_cvt_pk_bf16_f32 v192, v192, v193
    v_mfma_f32_16x16x32_bf16 v[188:191], v[88:91], v[224:227], v[188:191]
    v_cvt_pk_bf16_f32 v193, v194, v195
    v_mfma_f32_16x16x32_bf16 v[188:191], v[56:59], v[48:51], v[188:191]
    ds_write_b64 v9, v[192:193] offset:13344
    v_mfma_f32_16x16x32_bf16 v[188:191], v[76:79], v[68:71], v[188:191]
    v_mfma_f32_16x16x32_bf16 v[188:191], v[96:99], v[36:39], v[188:191]
    ds_read_b128 v[36:39], v22 offset:2560
    v_mfma_f32_16x16x32_bf16 v[176:179], v[96:99], v[68:71], v[176:179]
    v_mfma_f32_16x16x32_bf16 v[176:179], v[76:79], v[48:51], v[176:179]
    v_mfma_f32_16x16x32_bf16 v[176:179], v[56:59], v[224:227], v[176:179]
    v_mfma_f32_16x16x32_bf16 v[176:179], v[88:91], v[236:239], v[176:179]
    s_waitcnt lgkmcnt(2)
    v_mfma_f32_16x16x32_bf16 v[176:179], v[60:63], v[52:55], v[176:179]
    v_mfma_f32_16x16x32_bf16 v[176:179], v[128:131], v[124:127], v[176:179]
    v_cvt_pk_bf16_f32 v188, v188, v189
    v_mfma_f32_16x16x32_bf16 v[176:179], v[116:119], v[120:123], v[176:179]
    v_cvt_pk_bf16_f32 v189, v190, v191
    v_mfma_f32_16x16x32_bf16 v[176:179], v[104:107], v[40:43], v[176:179]
    v_mov_b32 v27, 26
    v_mfma_f32_16x16x32_bf16 v[176:179], v[92:95], v[240:243], v[176:179]
    ds_write_b64 v9, v[188:189] offset:13312
    v_mfma_f32_16x16x32_bf16 v[176:179], v[80:83], v[64:67], v[176:179]
    ds_write_b32 v25, v27
    v_mfma_f32_16x16x32_bf16 v[180:183], v[72:75], v[64:67], v[180:183]
    v_mfma_f32_16x16x32_bf16 v[180:183], v[32:35], v[240:243], v[180:183]
    v_mfma_f32_16x16x32_bf16 v[180:183], v[84:87], v[40:43], v[180:183]
    v_mfma_f32_16x16x32_bf16 v[180:183], v[108:111], v[120:123], v[180:183]
    v_mfma_f32_16x16x32_bf16 v[180:183], v[132:135], v[124:127], v[180:183]
    ds_read_b128 v[124:127], v3 offset:1280
    v_mfma_f32_16x16x32_bf16 v[180:183], v[100:103], v[52:55], v[180:183]
    v_cvt_pk_bf16_f32 v176, v176, v177
    v_mfma_f32_16x16x32_bf16 v[180:183], v[220:223], v[236:239], v[180:183]
    v_cvt_pk_bf16_f32 v177, v178, v179
    v_mfma_f32_16x16x32_bf16 v[180:183], v[44:47], v[224:227], v[180:183]
    ds_write_b64 v9, v[176:177] offset:9984
    v_mfma_f32_16x16x32_bf16 v[180:183], v[228:231], v[48:51], v[180:183]
    v_mfma_f32_16x16x32_bf16 v[180:183], v[232:235], v[68:71], v[180:183]
    ds_read_b128 v[68:71], v23 offset:1280
    v_mfma_f32_16x16x32_bf16 v[168:171], v[232:235], v[48:51], v[168:171]
    v_mfma_f32_16x16x32_bf16 v[168:171], v[228:231], v[224:227], v[168:171]
    v_mfma_f32_16x16x32_bf16 v[168:171], v[44:47], v[236:239], v[168:171]
    v_mfma_f32_16x16x32_bf16 v[168:171], v[220:223], v[52:55], v[168:171]
    s_waitcnt lgkmcnt(2)
    v_mfma_f32_16x16x32_bf16 v[168:171], v[100:103], v[36:39], v[168:171]
    v_mfma_f32_16x16x32_bf16 v[168:171], v[132:135], v[120:123], v[168:171]
    v_cvt_pk_bf16_f32 v180, v180, v181
    v_mfma_f32_16x16x32_bf16 v[168:171], v[108:111], v[40:43], v[168:171]
    v_cvt_pk_bf16_f32 v181, v182, v183
    v_mfma_f32_16x16x32_bf16 v[168:171], v[84:87], v[240:243], v[168:171]
    v_mov_b32 v27, 27
    v_mfma_f32_16x16x32_bf16 v[168:171], v[32:35], v[64:67], v[168:171]
    ds_write_b64 v9, v[180:181] offset:10016
    v_mfma_f32_16x16x32_bf16 v[168:171], v[72:75], v[112:115], v[168:171]
    ds_write_b32 v25, v27
    v_mfma_f32_16x16x32_bf16 v[164:167], v[80:83], v[112:115], v[164:167]
    v_mfma_f32_16x16x32_bf16 v[164:167], v[92:95], v[64:67], v[164:167]
    v_mfma_f32_16x16x32_bf16 v[164:167], v[104:107], v[240:243], v[164:167]
    v_mfma_f32_16x16x32_bf16 v[164:167], v[116:119], v[40:43], v[164:167]
    v_mfma_f32_16x16x32_bf16 v[164:167], v[128:131], v[120:123], v[164:167]
    ds_read_b128 v[120:123], v2 offset:0
    v_mfma_f32_16x16x32_bf16 v[164:167], v[60:63], v[36:39], v[164:167]
    v_cvt_pk_bf16_f32 v168, v168, v169
    v_mfma_f32_16x16x32_bf16 v[164:167], v[88:91], v[52:55], v[164:167]
    v_cvt_pk_bf16_f32 v169, v170, v171
    v_mfma_f32_16x16x32_bf16 v[164:167], v[56:59], v[236:239], v[164:167]
    ds_write_b64 v9, v[168:169] offset:6688
    v_mfma_f32_16x16x32_bf16 v[164:167], v[76:79], v[224:227], v[164:167]
    v_mfma_f32_16x16x32_bf16 v[164:167], v[96:99], v[48:51], v[164:167]
    ds_read_b128 v[48:51], v22 offset:0
    v_mfma_f32_16x16x32_bf16 v[152:155], v[96:99], v[224:227], v[152:155]
    v_mfma_f32_16x16x32_bf16 v[152:155], v[76:79], v[236:239], v[152:155]
    v_mfma_f32_16x16x32_bf16 v[152:155], v[56:59], v[52:55], v[152:155]
    v_mfma_f32_16x16x32_bf16 v[152:155], v[88:91], v[36:39], v[152:155]
    s_waitcnt lgkmcnt(2)
    v_mfma_f32_16x16x32_bf16 v[152:155], v[60:63], v[68:71], v[152:155]
    v_mfma_f32_16x16x32_bf16 v[152:155], v[128:131], v[40:43], v[152:155]
    v_cvt_pk_bf16_f32 v164, v164, v165
    v_mfma_f32_16x16x32_bf16 v[152:155], v[116:119], v[240:243], v[152:155]
    v_cvt_pk_bf16_f32 v165, v166, v167
    v_mfma_f32_16x16x32_bf16 v[152:155], v[104:107], v[64:67], v[152:155]
    v_mov_b32 v27, 28
    v_mfma_f32_16x16x32_bf16 v[152:155], v[92:95], v[112:115], v[152:155]
    ds_write_b64 v9, v[164:165] offset:6656
    v_mfma_f32_16x16x32_bf16 v[152:155], v[80:83], v[124:127], v[152:155]
    ds_write_b32 v25, v27
    v_mfma_f32_16x16x32_bf16 v[156:159], v[72:75], v[124:127], v[156:159]
    v_mfma_f32_16x16x32_bf16 v[156:159], v[32:35], v[112:115], v[156:159]
    v_mfma_f32_16x16x32_bf16 v[156:159], v[84:87], v[64:67], v[156:159]
    v_mfma_f32_16x16x32_bf16 v[156:159], v[108:111], v[240:243], v[156:159]
    v_mfma_f32_16x16x32_bf16 v[156:159], v[132:135], v[40:43], v[156:159]
    v_mfma_f32_16x16x32_bf16 v[156:159], v[100:103], v[68:71], v[156:159]
    v_mfma_f32_16x16x32_bf16 v[156:159], v[220:223], v[36:39], v[156:159]
    v_cvt_pk_bf16_f32 v152, v152, v153
    v_cvt_pk_bf16_f32 v153, v154, v155
    v_mfma_f32_16x16x32_bf16 v[156:159], v[44:47], v[52:55], v[156:159]
    ds_write_b64 v9, v[152:153] offset:3328
    v_mfma_f32_16x16x32_bf16 v[156:159], v[228:231], v[236:239], v[156:159]
    v_mfma_f32_16x16x32_bf16 v[156:159], v[232:235], v[224:227], v[156:159]
    v_mfma_f32_16x16x32_bf16 v[140:143], v[96:99], v[236:239], v[140:143]
    v_mfma_f32_16x16x32_bf16 v[140:143], v[76:79], v[52:55], v[140:143]
    v_mfma_f32_16x16x32_bf16 v[140:143], v[56:59], v[36:39], v[140:143]
    v_mfma_f32_16x16x32_bf16 v[140:143], v[88:91], v[68:71], v[140:143]
    s_waitcnt lgkmcnt(1)
    v_mfma_f32_16x16x32_bf16 v[140:143], v[60:63], v[48:51], v[140:143]
    v_mfma_f32_16x16x32_bf16 v[140:143], v[128:131], v[240:243], v[140:143]
    v_mfma_f32_16x16x32_bf16 v[140:143], v[116:119], v[64:67], v[140:143]
    v_cvt_pk_bf16_f32 v156, v156, v157
    v_cvt_pk_bf16_f32 v157, v158, v159
    v_mfma_f32_16x16x32_bf16 v[140:143], v[104:107], v[112:115], v[140:143]
    v_mov_b32 v27, 29
    ds_write_b64 v9, v[156:157] offset:3360
    v_mfma_f32_16x16x32_bf16 v[140:143], v[92:95], v[124:127], v[140:143]
    ds_write_b32 v25, v27
    v_mfma_f32_16x16x32_bf16 v[140:143], v[80:83], v[120:123], v[140:143]
    v_mfma_f32_16x16x32_bf16 v[144:147], v[72:75], v[120:123], v[144:147]
    v_mfma_f32_16x16x32_bf16 v[144:147], v[32:35], v[124:127], v[144:147]
    v_mfma_f32_16x16x32_bf16 v[144:147], v[84:87], v[112:115], v[144:147]
    v_mfma_f32_16x16x32_bf16 v[144:147], v[108:111], v[64:67], v[144:147]
    v_mfma_f32_16x16x32_bf16 v[144:147], v[132:135], v[240:243], v[144:147]
    v_mfma_f32_16x16x32_bf16 v[144:147], v[100:103], v[48:51], v[144:147]
    v_mfma_f32_16x16x32_bf16 v[144:147], v[220:223], v[68:71], v[144:147]
    v_mfma_f32_16x16x32_bf16 v[144:147], v[44:47], v[36:39], v[144:147]
    v_cvt_pk_bf16_f32 v140, v140, v141
    v_cvt_pk_bf16_f32 v141, v142, v143
    v_mfma_f32_16x16x32_bf16 v[144:147], v[228:231], v[52:55], v[144:147]
    s_add_u32 s48, s47, 0
    v_mfma_f32_16x16x32_bf16 v[144:147], v[232:235], v[236:239], v[144:147]
    s_nop 7
    v_cvt_pk_bf16_f32 v142, v144, v145
    v_cvt_pk_bf16_f32 v143, v146, v147
    s_nop 1
    v_permlane16_swap_b32 v140, v142
    v_permlane16_swap_b32 v141, v143
    buffer_store_dwordx4 v[140:143], v7, s[24:27], s48 offen sc0 sc1 nt
    s_endpgm
    .p2align 12
L_padf1:
    s_branch L_store2
    s_nop 0
L_fin1:
    ds_read_b64_tr_b16 v[76:77], v4 offset:0
    v_mfma_f32_16x16x32_bf16 v[144:147], v[96:99], v[36:39], v[144:147]
    ds_read_b64_tr_b16 v[78:79], v4 offset:768
    v_mfma_f32_16x16x32_bf16 v[144:147], v[84:87], v[32:35], v[144:147]
    ds_read_b128 v[32:35], v2 offset:0
    v_mfma_f32_16x16x32_bf16 v[156:159], v[84:87], v[36:39], v[156:159]
    ds_read_b64_tr_b16 v[88:89], v4 offset:6144
    v_mfma_f32_16x16x32_bf16 v[156:159], v[96:99], v[40:43], v[156:159]
    ds_read_b64_tr_b16 v[90:91], v4 offset:6912
    v_mfma_f32_16x16x32_bf16 v[156:159], v[108:111], v[44:47], v[156:159]
    ds_read_b128 v[36:39], v3 offset:1280
    v_mfma_f32_16x16x32_bf16 v[156:159], v[120:123], v[48:51], v[156:159]
    ds_read_b64_tr_b16 v[100:101], v4 offset:12288
    v_mfma_f32_16x16x32_bf16 v[156:159], v[132:135], v[52:55], v[156:159]
    ds_read_b64_tr_b16 v[102:103], v4 offset:13056
    v_mfma_f32_16x16x32_bf16 v[168:171], v[132:135], v[56:59], v[168:171]
    ds_read_b64_tr_b16 v[112:113], v4 offset:18432
    v_mfma_f32_16x16x32_bf16 v[168:171], v[120:123], v[52:55], v[168:171]
    ds_read_b64_tr_b16 v[114:115], v4 offset:19200
    v_mfma_f32_16x16x32_bf16 v[168:171], v[108:111], v[48:51], v[168:171]
    ds_read_b64_tr_b16 v[124:125], v4 offset:24576
    v_mfma_f32_16x16x32_bf16 v[168:171], v[96:99], v[44:47], v[168:171]
    ds_read_b64_tr_b16 v[126:127], v4 offset:25344
    v_mfma_f32_16x16x32_bf16 v[168:171], v[84:87], v[40:43], v[168:171]
    ds_read_b128 v[40:43], v2 offset:2560
    v_mfma_f32_16x16x32_bf16 v[180:183], v[84:87], v[44:47], v[180:183]
    ds_read_b128 v[44:47], v3 offset:3840
    v_mfma_f32_16x16x32_bf16 v[180:183], v[96:99], v[48:51], v[180:183]
    ds_read_b64_tr_b16 v[80:81], v5 offset:0
    v_mfma_f32_16x16x32_bf16 v[180:183], v[108:111], v[52:55], v[180:183]
    ds_read_b64_tr_b16 v[82:83], v5 offset:768
    v_mfma_f32_16x16x32_bf16 v[180:183], v[120:123], v[56:59], v[180:183]
    ds_read_b64_tr_b16 v[92:93], v5 offset:6144
    v_mfma_f32_16x16x32_bf16 v[180:183], v[132:135], v[60:63], v[180:183]
    ds_read_b64_tr_b16 v[94:95], v5 offset:6912
    v_mfma_f32_16x16x32_bf16 v[192:195], v[132:135], v[64:67], v[192:195]
    ds_read_b64_tr_b16 v[104:105], v5 offset:12288
    v_mfma_f32_16x16x32_bf16 v[192:195], v[120:123], v[60:63], v[192:195]
    ds_read_b64_tr_b16 v[106:107], v5 offset:13056
    v_mfma_f32_16x16x32_bf16 v[192:195], v[108:111], v[56:59], v[192:195]
    ds_read_b64_tr_b16 v[116:117], v5 offset:18432
    v_mfma_f32_16x16x32_bf16 v[192:195], v[96:99], v[52:55], v[192:195]
    ds_read_b64_tr_b16 v[118:119], v5 offset:19200
    v_mfma_f32_16x16x32_bf16 v[192:195], v[84:87], v[48:51], v[192:195]
    ds_read_b128 v[48:51], v2 offset:5120
    v_mfma_f32_16x16x32_bf16 v[204:207], v[84:87], v[52:55], v[204:207]
    ds_read_b128 v[52:55], v3 offset:6400
    v_mfma_f32_16x16x32_bf16 v[204:207], v[96:99], v[56:59], v[204:207]
    ds_read_b64_tr_b16 v[128:129], v5 offset:24576
    s_add_u32 s46, s46, 1
    v_mfma_f32_16x16x32_bf16 v[204:207], v[108:111], v[60:63], v[204:207]
    ds_read_b64_tr_b16 v[130:131], v5 offset:25344
    v_mfma_f32_16x16x32_bf16 v[204:207], v[120:123], v[64:67], v[204:207]
    v_mfma_f32_16x16x32_bf16 v[204:207], v[132:135], v[68:71], v[204:207]
    v_mfma_f32_16x16x32_bf16 v[216:219], v[132:135], v[72:75], v[216:219]
    ds_read_b128 v[72:75], v2 offset:12800
    v_mfma_f32_16x16x32_bf16 v[216:219], v[120:123], v[68:71], v[216:219]
    ds_read_b128 v[68:71], v3 offset:11520
    v_mfma_f32_16x16x32_bf16 v[216:219], v[108:111], v[64:67], v[216:219]
    ds_read_b128 v[64:67], v2 offset:10240
    v_mfma_f32_16x16x32_bf16 v[216:219], v[96:99], v[60:63], v[216:219]
    ds_read_b128 v[60:63], v3 offset:8960
    v_mfma_f32_16x16x32_bf16 v[216:219], v[84:87], v[56:59], v[216:219]
    ds_read_b128 v[56:59], v2 offset:7680
    s_waitcnt vmcnt(0)
    s_waitcnt lgkmcnt(6)
    v_mfma_f32_16x16x32_bf16 v[136:139], v[76:79], v[32:35], v[136:139]
    ds_read_b64_tr_b16 v[32:33], v4 offset:36864
    v_add_u32 v1, 64, v1
    v_mfma_f32_16x16x32_bf16 v[136:139], v[88:91], v[36:39], v[136:139]
    ds_read_b64_tr_b16 v[34:35], v4 offset:37632
    v_lshrrev_b32 v11, 3, v1
    v_mfma_f32_16x16x32_bf16 v[136:139], v[100:103], v[40:43], v[136:139]
    ds_read_b64_tr_b16 v[84:85], v4 offset:43008
    v_and_b32 v11, 32, v11
    v_mfma_f32_16x16x32_bf16 v[136:139], v[112:115], v[44:47], v[136:139]
    ds_read_b64_tr_b16 v[86:87], v4 offset:43776
    v_xor_b32 v22, v1, v11
    v_mfma_f32_16x16x32_bf16 v[136:139], v[124:127], v[48:51], v[136:139]
    ds_read_b64_tr_b16 v[108:109], v4 offset:49152
    v_xor_b32 v23, 32, v22
    v_mfma_f32_16x16x32_bf16 v[148:151], v[124:127], v[52:55], v[148:151]
    ds_read_b64_tr_b16 v[110:111], v4 offset:49920
    v_mfma_f32_16x16x32_bf16 v[148:151], v[112:115], v[48:51], v[148:151]
    ds_read_b128 v[72:75], v22 offset:7680
    v_mfma_f32_16x16x32_bf16 v[148:151], v[100:103], v[44:47], v[148:151]
    ds_read_b128 v[96:99], v23 offset:8960
    v_mfma_f32_16x16x32_bf16 v[148:151], v[88:91], v[40:43], v[148:151]
    ds_read_b128 v[120:123], v22 offset:10240
    v_mfma_f32_16x16x32_bf16 v[148:151], v[76:79], v[36:39], v[148:151]
    ds_read_b128 v[36:39], v23 offset:6400
    v_mfma_f32_16x16x32_bf16 v[160:163], v[76:79], v[40:43], v[160:163]
    ds_read_b64_tr_b16 v[40:41], v4 offset:30720
    v_mfma_f32_16x16x32_bf16 v[160:163], v[88:91], v[44:47], v[160:163]
    ds_read_b64_tr_b16 v[42:43], v4 offset:31488
    v_mfma_f32_16x16x32_bf16 v[160:163], v[100:103], v[48:51], v[160:163]
    ds_read_b64_tr_b16 v[132:133], v4 offset:55296
    v_mfma_f32_16x16x32_bf16 v[160:163], v[112:115], v[52:55], v[160:163]
    ds_read_b64_tr_b16 v[134:135], v4 offset:56064
    s_waitcnt lgkmcnt(8)
    v_mfma_f32_16x16x32_bf16 v[160:163], v[124:127], v[56:59], v[160:163]
    ds_read_b128 v[220:223], v23 offset:11520
    v_mfma_f32_16x16x32_bf16 v[172:175], v[124:127], v[60:63], v[172:175]
    ds_read_b64_tr_b16 v[224:225], v6 offset:18432
    v_mfma_f32_16x16x32_bf16 v[172:175], v[112:115], v[56:59], v[172:175]
    ds_read_b64_tr_b16 v[226:227], v6 offset:19200
    v_mfma_f32_16x16x32_bf16 v[172:175], v[100:103], v[52:55], v[172:175]
    ds_read_b128 v[228:231], v3 offset:3840
    v_mfma_f32_16x16x32_bf16 v[172:175], v[88:91], v[48:51], v[172:175]
    ds_read_b64_tr_b16 v[232:233], v6 offset:24576
    v_mfma_f32_16x16x32_bf16 v[172:175], v[76:79], v[44:47], v[172:175]
    ds_read_b128 v[44:47], v22 offset:5120
    v_mfma_f32_16x16x32_bf16 v[184:187], v[76:79], v[48:51], v[184:187]
    ds_read_b128 v[48:51], v23 offset:3840
    v_mfma_f32_16x16x32_bf16 v[184:187], v[88:91], v[52:55], v[184:187]
    ds_read_b64_tr_b16 v[234:235], v6 offset:25344
    v_mfma_f32_16x16x32_bf16 v[184:187], v[100:103], v[56:59], v[184:187]
    ds_read_b128 v[236:239], v2 offset:5120
    v_mfma_f32_16x16x32_bf16 v[184:187], v[112:115], v[60:63], v[184:187]
    ds_read_b128 v[240:243], v2 offset:7680
    v_mfma_f32_16x16x32_bf16 v[184:187], v[124:127], v[64:67], v[184:187]
    v_mfma_f32_16x16x32_bf16 v[196:199], v[124:127], v[68:71], v[196:199]
    ds_read_b64_tr_b16 v[68:69], v6 offset:12288
    v_mfma_f32_16x16x32_bf16 v[196:199], v[112:115], v[64:67], v[196:199]
    ds_read_b64_tr_b16 v[64:65], v6 offset:6144
    v_mfma_f32_16x16x32_bf16 v[196:199], v[100:103], v[60:63], v[196:199]
    ds_read_b64_tr_b16 v[60:61], v6 offset:49152
    v_mfma_f32_16x16x32_bf16 v[196:199], v[88:91], v[56:59], v[196:199]
    ds_read_b64_tr_b16 v[56:57], v6 offset:36864
    v_mfma_f32_16x16x32_bf16 v[196:199], v[76:79], v[52:55], v[196:199]
    ds_read_b128 v[52:55], v22 offset:2560
    s_waitcnt lgkmcnt(7)
    v_mfma_f32_16x16x32_bf16 v[196:199], v[40:43], v[36:39], v[196:199]
    ds_read_b128 v[76:79], v23 offset:1280
    v_mfma_f32_16x16x32_bf16 v[196:199], v[32:35], v[72:75], v[196:199]
    ds_read_b64_tr_b16 v[58:59], v6 offset:37632
    v_mfma_f32_16x16x32_bf16 v[196:199], v[84:87], v[96:99], v[196:199]
    ds_read_b64_tr_b16 v[88:89], v6 offset:43008
    v_mfma_f32_16x16x32_bf16 v[196:199], v[108:111], v[120:123], v[196:199]
    ds_read_b64_tr_b16 v[90:91], v6 offset:43776
    v_mfma_f32_16x16x32_bf16 v[196:199], v[132:135], v[220:223], v[196:199]
    ds_read_b64_tr_b16 v[220:221], v6 offset:30720
    v_mfma_f32_16x16x32_bf16 v[184:187], v[132:135], v[120:123], v[184:187]
    ds_read_b128 v[120:123], v22 offset:0
    v_mfma_f32_16x16x32_bf16 v[184:187], v[108:111], v[96:99], v[184:187]
    ds_read_b64_tr_b16 v[222:223], v6 offset:31488
    v_mfma_f32_16x16x32_bf16 v[184:187], v[84:87], v[72:75], v[184:187]
    ds_read_b64_tr_b16 v[62:63], v6 offset:49920
    v_mfma_f32_16x16x32_bf16 v[184:187], v[32:35], v[36:39], v[184:187]
    ds_read_b128 v[100:103], v2 offset:0
    v_mfma_f32_16x16x32_bf16 v[184:187], v[40:43], v[44:47], v[184:187]
    ds_read_b64_tr_b16 v[66:67], v6 offset:6912
    v_mfma_f32_16x16x32_bf16 v[172:175], v[40:43], v[48:51], v[172:175]
    ds_read_b128 v[112:115], v3 offset:1280
    v_mfma_f32_16x16x32_bf16 v[172:175], v[32:35], v[44:47], v[172:175]
    ds_read_b64_tr_b16 v[70:71], v6 offset:13056
    v_mfma_f32_16x16x32_bf16 v[172:175], v[84:87], v[36:39], v[172:175]
    ds_read_b128 v[124:127], v2 offset:2560
    v_mfma_f32_16x16x32_bf16 v[172:175], v[108:111], v[72:75], v[172:175]
    v_cvt_pk_bf16_f32 v196, v196, v197
    v_mfma_f32_16x16x32_bf16 v[172:175], v[132:135], v[96:99], v[172:175]
    ds_read_b64_tr_b16 v[96:97], v6 offset:55296
    v_mfma_f32_16x16x32_bf16 v[160:163], v[132:135], v[72:75], v[160:163]
    ds_read_b64_tr_b16 v[98:99], v6 offset:56064
    v_mfma_f32_16x16x32_bf16 v[160:163], v[108:111], v[36:39], v[160:163]
    ds_read_b64_tr_b16 v[72:73], v6 offset:0
    v_mfma_f32_16x16x32_bf16 v[160:163], v[84:87], v[44:47], v[160:163]
    ds_read_b64_tr_b16 v[74:75], v6 offset:768
    v_mfma_f32_16x16x32_bf16 v[160:163], v[32:35], v[48:51], v[160:163]
    v_cvt_pk_bf16_f32 v197, v198, v199
    s_waitcnt lgkmcnt(6)
    v_mfma_f32_16x16x32_bf16 v[160:163], v[40:43], v[52:55], v[160:163]
    v_mov_b32 v27, 16
    v_mfma_f32_16x16x32_bf16 v[148:151], v[40:43], v[76:79], v[148:151]
    ds_write_b64 v10, v[196:197] offset:16640
    v_mfma_f32_16x16x32_bf16 v[148:151], v[32:35], v[52:55], v[148:151]
    ds_write_b32 v25, v27
    v_mfma_f32_16x16x32_bf16 v[148:151], v[84:87], v[48:51], v[148:151]
    v_cvt_pk_bf16_f32 v184, v184, v185
    v_mfma_f32_16x16x32_bf16 v[148:151], v[108:111], v[44:47], v[148:151]
    v_cvt_pk_bf16_f32 v185, v186, v187
    v_mfma_f32_16x16x32_bf16 v[148:151], v[132:135], v[36:39], v[148:151]
    ds_read_b128 v[36:39], v23 offset:6400
    v_mfma_f32_16x16x32_bf16 v[136:139], v[132:135], v[44:47], v[136:139]
    ds_read_b128 v[132:135], v22 offset:7680
    v_mfma_f32_16x16x32_bf16 v[136:139], v[108:111], v[48:51], v[136:139]
    ds_read_b64_tr_b16 v[108:109], v5 offset:30720
    v_mfma_f32_16x16x32_bf16 v[136:139], v[84:87], v[52:55], v[136:139]
    ds_read_b64_tr_b16 v[84:85], v5 offset:36864
    v_mfma_f32_16x16x32_bf16 v[136:139], v[32:35], v[76:79], v[136:139]
    ds_read_b64_tr_b16 v[32:33], v5 offset:43008
    v_mfma_f32_16x16x32_bf16 v[136:139], v[40:43], v[120:123], v[136:139]
    ds_read_b128 v[40:43], v3 offset:6400
    v_mfma_f32_16x16x32_bf16 v[144:147], v[220:223], v[120:123], v[144:147]
    ds_read_b64_tr_b16 v[120:121], v5 offset:49152
    v_mfma_f32_16x16x32_bf16 v[144:147], v[56:59], v[76:79], v[144:147]
    ds_read_b64_tr_b16 v[122:123], v5 offset:49920
    v_mfma_f32_16x16x32_bf16 v[144:147], v[88:91], v[52:55], v[144:147]
    ds_read_b64_tr_b16 v[34:35], v5 offset:43776
    v_mfma_f32_16x16x32_bf16 v[144:147], v[60:63], v[48:51], v[144:147]
    ds_read_b64_tr_b16 v[86:87], v5 offset:37632
    s_waitcnt lgkmcnt(8)
    v_mfma_f32_16x16x32_bf16 v[144:147], v[96:99], v[44:47], v[144:147]
    ds_read_b64_tr_b16 v[110:111], v5 offset:31488
    v_mfma_f32_16x16x32_bf16 v[144:147], v[72:75], v[100:103], v[144:147]
    ds_read_b64_tr_b16 v[100:101], v5 offset:55296
    v_mfma_f32_16x16x32_bf16 v[144:147], v[64:67], v[112:115], v[144:147]
    ds_read_b64_tr_b16 v[102:103], v5 offset:56064
    v_mfma_f32_16x16x32_bf16 v[144:147], v[68:71], v[124:127], v[144:147]
    v_mov_b32 v27, 17
    v_mfma_f32_16x16x32_bf16 v[144:147], v[224:227], v[228:231], v[144:147]
    ds_write_b64 v10, v[184:185] offset:13312
    v_mfma_f32_16x16x32_bf16 v[144:147], v[232:235], v[236:239], v[144:147]
    ds_write_b32 v25, v27
    v_mfma_f32_16x16x32_bf16 v[156:159], v[220:223], v[76:79], v[156:159]
    v_cvt_pk_bf16_f32 v172, v172, v173
    v_mfma_f32_16x16x32_bf16 v[156:159], v[56:59], v[52:55], v[156:159]
    v_cvt_pk_bf16_f32 v173, v174, v175
    v_mfma_f32_16x16x32_bf16 v[156:159], v[88:91], v[48:51], v[156:159]
    v_mov_b32 v27, 18
    v_mfma_f32_16x16x32_bf16 v[156:159], v[60:63], v[44:47], v[156:159]
    ds_write_b64 v10, v[172:173] offset:9984
    v_mfma_f32_16x16x32_bf16 v[156:159], v[96:99], v[36:39], v[156:159]
    ds_write_b32 v25, v27
    v_mfma_f32_16x16x32_bf16 v[156:159], v[72:75], v[112:115], v[156:159]
    v_cvt_pk_bf16_f32 v160, v160, v161
    v_mfma_f32_16x16x32_bf16 v[156:159], v[64:67], v[124:127], v[156:159]
    v_cvt_pk_bf16_f32 v161, v162, v163
    v_mfma_f32_16x16x32_bf16 v[156:159], v[68:71], v[228:231], v[156:159]
    v_mov_b32 v27, 19
    v_mfma_f32_16x16x32_bf16 v[156:159], v[224:227], v[236:239], v[156:159]
    ds_write_b64 v10, v[160:161] offset:6656
    s_waitcnt lgkmcnt(3)
    v_mfma_f32_16x16x32_bf16 v[156:159], v[232:235], v[40:43], v[156:159]
    ds_write_b32 v25, v27
    v_mfma_f32_16x16x32_bf16 v[152:155], v[128:131], v[40:43], v[152:155]
    v_cvt_pk_bf16_f32 v148, v148, v149
    v_mfma_f32_16x16x32_bf16 v[152:155], v[116:119], v[236:239], v[152:155]
    v_cvt_pk_bf16_f32 v149, v150, v151
    v_mfma_f32_16x16x32_bf16 v[152:155], v[104:107], v[228:231], v[152:155]
    v_mov_b32 v27, 20
    v_mfma_f32_16x16x32_bf16 v[152:155], v[92:95], v[124:127], v[152:155]
    ds_write_b64 v10, v[148:149] offset:3328
    v_mfma_f32_16x16x32_bf16 v[152:155], v[80:83], v[112:115], v[152:155]
    ds_read_b128 v[112:115], v3 offset:8960
    v_mfma_f32_16x16x32_bf16 v[152:155], v[100:103], v[36:39], v[152:155]
    ds_write_b32 v25, v27
    v_mfma_f32_16x16x32_bf16 v[152:155], v[120:123], v[44:47], v[152:155]
    v_cvt_pk_bf16_f32 v136, v136, v137
    v_mfma_f32_16x16x32_bf16 v[152:155], v[32:35], v[48:51], v[152:155]
    v_cvt_pk_bf16_f32 v137, v138, v139
    v_mfma_f32_16x16x32_bf16 v[152:155], v[84:87], v[52:55], v[152:155]
    v_mov_b32 v27, 21
    v_mfma_f32_16x16x32_bf16 v[152:155], v[108:111], v[76:79], v[152:155]
    ds_read_b128 v[76:79], v23 offset:8960
    v_mfma_f32_16x16x32_bf16 v[164:167], v[108:111], v[52:55], v[164:167]
    ds_write_b64 v10, v[136:137] offset:0
    v_mfma_f32_16x16x32_bf16 v[164:167], v[84:87], v[48:51], v[164:167]
    ds_write_b32 v25, v27
    v_mfma_f32_16x16x32_bf16 v[164:167], v[32:35], v[44:47], v[164:167]
    v_cvt_pk_bf16_f32 v144, v144, v145
    v_mfma_f32_16x16x32_bf16 v[164:167], v[120:123], v[36:39], v[164:167]
    v_cvt_pk_bf16_f32 v145, v146, v147
    v_mfma_f32_16x16x32_bf16 v[164:167], v[100:103], v[132:135], v[164:167]
    v_mov_b32 v27, 24
    v_mfma_f32_16x16x32_bf16 v[164:167], v[80:83], v[124:127], v[164:167]
    ds_write_b64 v9, v[144:145] offset:32
    v_mfma_f32_16x16x32_bf16 v[164:167], v[92:95], v[228:231], v[164:167]
    ds_write_b32 v25, v27
    v_mfma_f32_16x16x32_bf16 v[164:167], v[104:107], v[236:239], v[164:167]
    v_cvt_pk_bf16_f32 v156, v156, v157
    v_mfma_f32_16x16x32_bf16 v[164:167], v[116:119], v[40:43], v[164:167]
    v_cvt_pk_bf16_f32 v157, v158, v159
    v_mfma_f32_16x16x32_bf16 v[164:167], v[128:131], v[240:243], v[164:167]
    ds_write_b64 v9, v[156:157] offset:3360
    v_mfma_f32_16x16x32_bf16 v[168:171], v[232:235], v[240:243], v[168:171]
    v_cvt_pk_bf16_f32 v152, v152, v153
    v_mfma_f32_16x16x32_bf16 v[168:171], v[224:227], v[40:43], v[168:171]
    v_cvt_pk_bf16_f32 v153, v154, v155
    v_mfma_f32_16x16x32_bf16 v[168:171], v[68:71], v[236:239], v[168:171]
    v_mov_b32 v27, 25
    v_mfma_f32_16x16x32_bf16 v[168:171], v[64:67], v[228:231], v[168:171]
    ds_write_b64 v9, v[152:153] offset:3328
    v_mfma_f32_16x16x32_bf16 v[168:171], v[72:75], v[124:127], v[168:171]
    ds_read_b128 v[124:127], v2 offset:10240
    v_mfma_f32_16x16x32_bf16 v[168:171], v[96:99], v[132:135], v[168:171]
    ds_write_b32 v25, v27
    v_mfma_f32_16x16x32_bf16 v[168:171], v[60:63], v[36:39], v[168:171]
    v_cvt_pk_bf16_f32 v164, v164, v165
    v_mfma_f32_16x16x32_bf16 v[168:171], v[88:91], v[44:47], v[168:171]
    v_cvt_pk_bf16_f32 v165, v166, v167
    v_mfma_f32_16x16x32_bf16 v[168:171], v[56:59], v[48:51], v[168:171]
    ds_write_b64 v9, v[164:165] offset:6656
    v_mfma_f32_16x16x32_bf16 v[168:171], v[220:223], v[52:55], v[168:171]
    ds_read_b128 v[52:55], v22 offset:10240
    v_mfma_f32_16x16x32_bf16 v[180:183], v[220:223], v[48:51], v[180:183]
    v_mfma_f32_16x16x32_bf16 v[180:183], v[56:59], v[44:47], v[180:183]
    v_mfma_f32_16x16x32_bf16 v[180:183], v[88:91], v[36:39], v[180:183]
    v_mfma_f32_16x16x32_bf16 v[180:183], v[60:63], v[132:135], v[180:183]
    s_waitcnt lgkmcnt(2)
    v_mfma_f32_16x16x32_bf16 v[180:183], v[96:99], v[76:79], v[180:183]
    v_mfma_f32_16x16x32_bf16 v[180:183], v[72:75], v[228:231], v[180:183]
    v_cvt_pk_bf16_f32 v168, v168, v169
    v_mfma_f32_16x16x32_bf16 v[180:183], v[64:67], v[236:239], v[180:183]
    v_cvt_pk_bf16_f32 v169, v170, v171
    v_mfma_f32_16x16x32_bf16 v[180:183], v[68:71], v[40:43], v[180:183]
    v_mov_b32 v27, 26
    v_mfma_f32_16x16x32_bf16 v[180:183], v[224:227], v[240:243], v[180:183]
    ds_write_b64 v9, v[168:169] offset:6688
    v_mfma_f32_16x16x32_bf16 v[180:183], v[232:235], v[112:115], v[180:183]
    ds_write_b32 v25, v27
    v_mfma_f32_16x16x32_bf16 v[176:179], v[128:131], v[112:115], v[176:179]
    v_mfma_f32_16x16x32_bf16 v[176:179], v[116:119], v[240:243], v[176:179]
    v_mfma_f32_16x16x32_bf16 v[176:179], v[104:107], v[40:43], v[176:179]
    v_mfma_f32_16x16x32_bf16 v[176:179], v[92:95], v[236:239], v[176:179]
    v_mfma_f32_16x16x32_bf16 v[176:179], v[80:83], v[228:231], v[176:179]
    ds_read_b128 v[228:231], v3 offset:11520
    v_mfma_f32_16x16x32_bf16 v[176:179], v[100:103], v[76:79], v[176:179]
    v_cvt_pk_bf16_f32 v180, v180, v181
    v_mfma_f32_16x16x32_bf16 v[176:179], v[120:123], v[132:135], v[176:179]
    v_cvt_pk_bf16_f32 v181, v182, v183
    v_mfma_f32_16x16x32_bf16 v[176:179], v[32:35], v[36:39], v[176:179]
    ds_write_b64 v9, v[180:181] offset:10016
    v_mfma_f32_16x16x32_bf16 v[176:179], v[84:87], v[44:47], v[176:179]
    v_mfma_f32_16x16x32_bf16 v[176:179], v[108:111], v[48:51], v[176:179]
    ds_read_b128 v[48:51], v23 offset:11520
    v_mfma_f32_16x16x32_bf16 v[188:191], v[108:111], v[44:47], v[188:191]
    v_mfma_f32_16x16x32_bf16 v[188:191], v[84:87], v[36:39], v[188:191]
    v_mfma_f32_16x16x32_bf16 v[188:191], v[32:35], v[132:135], v[188:191]
    v_mfma_f32_16x16x32_bf16 v[188:191], v[120:123], v[76:79], v[188:191]
    s_waitcnt lgkmcnt(2)
    v_mfma_f32_16x16x32_bf16 v[188:191], v[100:103], v[52:55], v[188:191]
    v_mfma_f32_16x16x32_bf16 v[188:191], v[80:83], v[236:239], v[188:191]
    v_cvt_pk_bf16_f32 v176, v176, v177
    v_mfma_f32_16x16x32_bf16 v[188:191], v[92:95], v[40:43], v[188:191]
    v_cvt_pk_bf16_f32 v177, v178, v179
    v_mfma_f32_16x16x32_bf16 v[188:191], v[104:107], v[240:243], v[188:191]
    v_mov_b32 v27, 27
    v_mfma_f32_16x16x32_bf16 v[188:191], v[116:119], v[112:115], v[188:191]
    ds_write_b64 v9, v[176:177] offset:9984
    v_mfma_f32_16x16x32_bf16 v[188:191], v[128:131], v[124:127], v[188:191]
    ds_write_b32 v25, v27
    v_mfma_f32_16x16x32_bf16 v[192:195], v[232:235], v[124:127], v[192:195]
    v_mfma_f32_16x16x32_bf16 v[192:195], v[224:227], v[112:115], v[192:195]
    v_mfma_f32_16x16x32_bf16 v[192:195], v[68:71], v[240:243], v[192:195]
    v_mfma_f32_16x16x32_bf16 v[192:195], v[64:67], v[40:43], v[192:195]
    v_mfma_f32_16x16x32_bf16 v[192:195], v[72:75], v[236:239], v[192:195]
    ds_read_b128 v[236:239], v2 offset:12800
    v_mfma_f32_16x16x32_bf16 v[192:195], v[96:99], v[52:55], v[192:195]
    v_cvt_pk_bf16_f32 v188, v188, v189
    v_mfma_f32_16x16x32_bf16 v[192:195], v[60:63], v[76:79], v[192:195]
    v_cvt_pk_bf16_f32 v189, v190, v191
    v_mfma_f32_16x16x32_bf16 v[192:195], v[88:91], v[132:135], v[192:195]
    ds_write_b64 v9, v[188:189] offset:13312
    v_mfma_f32_16x16x32_bf16 v[192:195], v[56:59], v[36:39], v[192:195]
    v_mfma_f32_16x16x32_bf16 v[192:195], v[220:223], v[44:47], v[192:195]
    ds_read_b128 v[44:47], v22 offset:12800
    v_mfma_f32_16x16x32_bf16 v[204:207], v[220:223], v[36:39], v[204:207]
    v_mfma_f32_16x16x32_bf16 v[204:207], v[56:59], v[132:135], v[204:207]
    v_mfma_f32_16x16x32_bf16 v[204:207], v[88:91], v[76:79], v[204:207]
    v_mfma_f32_16x16x32_bf16 v[204:207], v[60:63], v[52:55], v[204:207]
    s_waitcnt lgkmcnt(2)
    v_mfma_f32_16x16x32_bf16 v[204:207], v[96:99], v[48:51], v[204:207]
    v_mfma_f32_16x16x32_bf16 v[204:207], v[72:75], v[40:43], v[204:207]
    v_cvt_pk_bf16_f32 v192, v192, v193
    v_mfma_f32_16x16x32_bf16 v[204:207], v[64:67], v[240:243], v[204:207]
    v_cvt_pk_bf16_f32 v193, v194, v195
    v_mfma_f32_16x16x32_bf16 v[204:207], v[68:71], v[112:115], v[204:207]
    v_mov_b32 v27, 28
    v_mfma_f32_16x16x32_bf16 v[204:207], v[224:227], v[124:127], v[204:207]
    ds_write_b64 v9, v[192:193] offset:13344
    v_mfma_f32_16x16x32_bf16 v[204:207], v[232:235], v[228:231], v[204:207]
    ds_write_b32 v25, v27
    v_mfma_f32_16x16x32_bf16 v[200:203], v[128:131], v[228:231], v[200:203]
    v_mfma_f32_16x16x32_bf16 v[200:203], v[116:119], v[124:127], v[200:203]
    v_mfma_f32_16x16x32_bf16 v[200:203], v[104:107], v[112:115], v[200:203]
    v_mfma_f32_16x16x32_bf16 v[200:203], v[92:95], v[240:243], v[200:203]
    v_mfma_f32_16x16x32_bf16 v[200:203], v[80:83], v[40:43], v[200:203]
    v_mfma_f32_16x16x32_bf16 v[200:203], v[100:103], v[48:51], v[200:203]
    v_mfma_f32_16x16x32_bf16 v[200:203], v[120:123], v[52:55], v[200:203]
    v_cvt_pk_bf16_f32 v204, v204, v205
    v_cvt_pk_bf16_f32 v205, v206, v207
    v_mfma_f32_16x16x32_bf16 v[200:203], v[32:35], v[76:79], v[200:203]
    ds_write_b64 v9, v[204:205] offset:16672
    v_mfma_f32_16x16x32_bf16 v[200:203], v[84:87], v[132:135], v[200:203]
    v_mfma_f32_16x16x32_bf16 v[200:203], v[108:111], v[36:39], v[200:203]
    v_mfma_f32_16x16x32_bf16 v[212:215], v[108:111], v[132:135], v[212:215]
    v_mfma_f32_16x16x32_bf16 v[212:215], v[84:87], v[76:79], v[212:215]
    v_mfma_f32_16x16x32_bf16 v[212:215], v[32:35], v[52:55], v[212:215]
    v_mfma_f32_16x16x32_bf16 v[212:215], v[120:123], v[48:51], v[212:215]
    s_waitcnt lgkmcnt(1)
    v_mfma_f32_16x16x32_bf16 v[212:215], v[100:103], v[44:47], v[212:215]
    v_mfma_f32_16x16x32_bf16 v[212:215], v[80:83], v[240:243], v[212:215]
    v_mfma_f32_16x16x32_bf16 v[212:215], v[92:95], v[112:115], v[212:215]
    v_cvt_pk_bf16_f32 v200, v200, v201
    v_cvt_pk_bf16_f32 v201, v202, v203
    v_mfma_f32_16x16x32_bf16 v[212:215], v[104:107], v[124:127], v[212:215]
    v_mov_b32 v27, 29
    ds_write_b64 v9, v[200:201] offset:16640
    v_mfma_f32_16x16x32_bf16 v[212:215], v[116:119], v[228:231], v[212:215]
    ds_write_b32 v25, v27
    v_mfma_f32_16x16x32_bf16 v[212:215], v[128:131], v[236:239], v[212:215]
    v_mfma_f32_16x16x32_bf16 v[216:219], v[232:235], v[236:239], v[216:219]
    v_mfma_f32_16x16x32_bf16 v[216:219], v[224:227], v[228:231], v[216:219]
    v_mfma_f32_16x16x32_bf16 v[216:219], v[68:71], v[124:127], v[216:219]
    v_mfma_f32_16x16x32_bf16 v[216:219], v[64:67], v[112:115], v[216:219]
    v_mfma_f32_16x16x32_bf16 v[216:219], v[72:75], v[240:243], v[216:219]
    v_mfma_f32_16x16x32_bf16 v[216:219], v[96:99], v[44:47], v[216:219]
    v_mfma_f32_16x16x32_bf16 v[216:219], v[60:63], v[48:51], v[216:219]
    v_mfma_f32_16x16x32_bf16 v[216:219], v[88:91], v[52:55], v[216:219]
    v_cvt_pk_bf16_f32 v212, v212, v213
    v_cvt_pk_bf16_f32 v213, v214, v215
    v_mfma_f32_16x16x32_bf16 v[216:219], v[56:59], v[76:79], v[216:219]
    s_add_u32 s48, s47, 516096
    v_mfma_f32_16x16x32_bf16 v[216:219], v[220:223], v[132:135], v[216:219]
    s_nop 7
    v_cvt_pk_bf16_f32 v214, v216, v217
    v_cvt_pk_bf16_f32 v215, v218, v219
    s_nop 1
    v_permlane16_swap_b32 v212, v214
    v_permlane16_swap_b32 v213, v215
    buffer_store_dwordx4 v[212:215], v7, s[24:27], s48 offen sc0 sc1 nt
    s_endpgm
    .p2align 12
L_padf2:
    s_branch L_store2
    s_nop 0
L_fin2:
    ds_read_b64_tr_b16 v[76:77], v4 offset:0
    v_mfma_f32_16x16x32_bf16 v[212:215], v[92:95], v[60:63], v[212:215]
    ds_read_b64_tr_b16 v[78:79], v4 offset:768
    v_mfma_f32_16x16x32_bf16 v[212:215], v[80:83], v[56:59], v[212:215]
    ds_read_b128 v[32:35], v2 offset:0
    v_mfma_f32_16x16x32_bf16 v[156:159], v[84:87], v[36:39], v[156:159]
    ds_read_b64_tr_b16 v[88:89], v4 offset:6144
    v_mfma_f32_16x16x32_bf16 v[156:159], v[96:99], v[40:43], v[156:159]
    ds_read_b64_tr_b16 v[90:91], v4 offset:6912
    v_mfma_f32_16x16x32_bf16 v[156:159], v[108:111], v[44:47], v[156:159]
    ds_read_b128 v[36:39], v3 offset:1280
    v_mfma_f32_16x16x32_bf16 v[156:159], v[120:123], v[48:51], v[156:159]
    ds_read_b64_tr_b16 v[100:101], v4 offset:12288
    v_mfma_f32_16x16x32_bf16 v[156:159], v[132:135], v[52:55], v[156:159]
    ds_read_b64_tr_b16 v[102:103], v4 offset:13056
    v_mfma_f32_16x16x32_bf16 v[168:171], v[132:135], v[56:59], v[168:171]
    ds_read_b64_tr_b16 v[112:113], v4 offset:18432
    v_mfma_f32_16x16x32_bf16 v[168:171], v[120:123], v[52:55], v[168:171]
    ds_read_b64_tr_b16 v[114:115], v4 offset:19200
    v_mfma_f32_16x16x32_bf16 v[168:171], v[108:111], v[48:51], v[168:171]
    ds_read_b64_tr_b16 v[124:125], v4 offset:24576
    v_mfma_f32_16x16x32_bf16 v[168:171], v[96:99], v[44:47], v[168:171]
    ds_read_b64_tr_b16 v[126:127], v4 offset:25344
    v_mfma_f32_16x16x32_bf16 v[168:171], v[84:87], v[40:43], v[168:171]
    ds_read_b128 v[40:43], v2 offset:2560
    v_mfma_f32_16x16x32_bf16 v[180:183], v[84:87], v[44:47], v[180:183]
    ds_read_b128 v[44:47], v3 offset:3840
    v_mfma_f32_16x16x32_bf16 v[180:183], v[96:99], v[48:51], v[180:183]
    ds_read_b64_tr_b16 v[80:81], v5 offset:0
    v_mfma_f32_16x16x32_bf16 v[180:183], v[108:111], v[52:55], v[180:183]
    ds_read_b64_tr_b16 v[82:83], v5 offset:768
    v_mfma_f32_16x16x32_bf16 v[180:183], v[120:123], v[56:59], v[180:183]
    ds_read_b64_tr_b16 v[92:93], v5 offset:6144
    v_mfma_f32_16x16x32_bf16 v[180:183], v[132:135], v[60:63], v[180:183]
    ds_read_b64_tr_b16 v[94:95], v5 offset:6912
    v_mfma_f32_16x16x32_bf16 v[192:195], v[132:135], v[64:67], v[192:195]
    ds_read_b64_tr_b16 v[104:105], v5 offset:12288
    v_mfma_f32_16x16x32_bf16 v[192:195], v[120:123], v[60:63], v[192:195]
    ds_read_b64_tr_b16 v[106:107], v5 offset:13056
    v_mfma_f32_16x16x32_bf16 v[192:195], v[108:111], v[56:59], v[192:195]
    ds_read_b64_tr_b16 v[116:117], v5 offset:18432
    v_mfma_f32_16x16x32_bf16 v[192:195], v[96:99], v[52:55], v[192:195]
    ds_read_b64_tr_b16 v[118:119], v5 offset:19200
    v_mfma_f32_16x16x32_bf16 v[192:195], v[84:87], v[48:51], v[192:195]
    ds_read_b128 v[48:51], v2 offset:5120
    v_mfma_f32_16x16x32_bf16 v[204:207], v[84:87], v[52:55], v[204:207]
    ds_read_b128 v[52:55], v3 offset:6400
    v_mfma_f32_16x16x32_bf16 v[204:207], v[96:99], v[56:59], v[204:207]
    ds_read_b64_tr_b16 v[128:129], v5 offset:24576
    s_add_u32 s46, s46, 1
    v_mfma_f32_16x16x32_bf16 v[204:207], v[108:111], v[60:63], v[204:207]
    ds_read_b64_tr_b16 v[130:131], v5 offset:25344
    v_mfma_f32_16x16x32_bf16 v[204:207], v[120:123], v[64:67], v[204:207]
    v_mfma_f32_16x16x32_bf16 v[204:207], v[132:135], v[68:71], v[204:207]
    v_mfma_f32_16x16x32_bf16 v[216:219], v[132:135], v[72:75], v[216:219]
    ds_read_b128 v[72:75], v2 offset:12800
    v_mfma_f32_16x16x32_bf16 v[216:219], v[120:123], v[68:71], v[216:219]
    ds_read_b128 v[68:71], v3 offset:11520
    v_mfma_f32_16x16x32_bf16 v[216:219], v[108:111], v[64:67], v[216:219]
    ds_read_b128 v[64:67], v2 offset:10240
    v_mfma_f32_16x16x32_bf16 v[216:219], v[96:99], v[60:63], v[216:219]
    ds_read_b128 v[60:63], v3 offset:8960
    v_mfma_f32_16x16x32_bf16 v[216:219], v[84:87], v[56:59], v[216:219]
    ds_read_b128 v[56:59], v2 offset:7680
    s_waitcnt vmcnt(0)
    s_waitcnt lgkmcnt(6)
    v_mfma_f32_16x16x32_bf16 v[136:139], v[76:79], v[32:35], v[136:139]
    ds_read_b64_tr_b16 v[32:33], v4 offset:36864
    v_add_u32 v1, 64, v1
    v_mfma_f32_16x16x32_bf16 v[136:139], v[88:91], v[36:39], v[136:139]
    ds_read_b64_tr_b16 v[34:35], v4 offset:37632
    v_lshrrev_b32 v11, 3, v1
    v_mfma_f32_16x16x32_bf16 v[136:139], v[100:103], v[40:43], v[136:139]
    ds_read_b64_tr_b16 v[96:97], v4 offset:43008
    v_and_b32 v11, 32, v11
    v_mfma_f32_16x16x32_bf16 v[136:139], v[112:115], v[44:47], v[136:139]
    ds_read_b64_tr_b16 v[98:99], v4 offset:43776
    v_xor_b32 v22, v1, v11
    v_mfma_f32_16x16x32_bf16 v[136:139], v[124:127], v[48:51], v[136:139]
    ds_read_b64_tr_b16 v[120:121], v4 offset:49152
    v_xor_b32 v23, 32, v22
    v_mfma_f32_16x16x32_bf16 v[148:151], v[124:127], v[52:55], v[148:151]
    ds_read_b64_tr_b16 v[122:123], v4 offset:49920
    v_mfma_f32_16x16x32_bf16 v[148:151], v[112:115], v[48:51], v[148:151]
    ds_read_b128 v[84:87], v23 offset:8960
    v_mfma_f32_16x16x32_bf16 v[148:151], v[100:103], v[44:47], v[148:151]
    ds_read_b128 v[108:111], v22 offset:10240
    v_mfma_f32_16x16x32_bf16 v[148:151], v[88:91], v[40:43], v[148:151]
    ds_read_b128 v[132:135], v23 offset:11520
    v_mfma_f32_16x16x32_bf16 v[148:151], v[76:79], v[36:39], v[148:151]
    ds_read_b128 v[36:39], v22 offset:7680
    v_mfma_f32_16x16x32_bf16 v[160:163], v[76:79], v[40:43], v[160:163]
    ds_read_b64_tr_b16 v[40:41], v4 offset:30720
    v_mfma_f32_16x16x32_bf16 v[160:163], v[88:91], v[44:47], v[160:163]
    ds_read_b64_tr_b16 v[42:43], v4 offset:31488
    v_mfma_f32_16x16x32_bf16 v[160:163], v[100:103], v[48:51], v[160:163]
    ds_read_b128 v[220:223], v22 offset:12800
    v_mfma_f32_16x16x32_bf16 v[160:163], v[112:115], v[52:55], v[160:163]
    ds_read_b128 v[224:227], v22 offset:5120
    s_waitcnt lgkmcnt(8)
    v_mfma_f32_16x16x32_bf16 v[160:163], v[124:127], v[56:59], v[160:163]
    ds_read_b64_tr_b16 v[228:229], v6 offset:12288
    v_mfma_f32_16x16x32_bf16 v[172:175], v[124:127], v[60:63], v[172:175]
    ds_read_b64_tr_b16 v[230:231], v6 offset:13056
    v_mfma_f32_16x16x32_bf16 v[172:175], v[112:115], v[56:59], v[172:175]
    ds_read_b64_tr_b16 v[232:233], v6 offset:6144
    v_mfma_f32_16x16x32_bf16 v[172:175], v[100:103], v[52:55], v[172:175]
    ds_read_b64_tr_b16 v[234:235], v6 offset:6912
    v_mfma_f32_16x16x32_bf16 v[172:175], v[88:91], v[48:51], v[172:175]
    ds_read_b64_tr_b16 v[236:237], v6 offset:0
    v_mfma_f32_16x16x32_bf16 v[172:175], v[76:79], v[44:47], v[172:175]
    ds_read_b64_tr_b16 v[44:45], v4 offset:55296
    v_mfma_f32_16x16x32_bf16 v[184:187], v[76:79], v[48:51], v[184:187]
    ds_read_b64_tr_b16 v[46:47], v4 offset:56064
    v_mfma_f32_16x16x32_bf16 v[184:187], v[88:91], v[52:55], v[184:187]
    ds_read_b128 v[48:51], v23 offset:6400
    v_mfma_f32_16x16x32_bf16 v[184:187], v[100:103], v[56:59], v[184:187]
    ds_read_b64_tr_b16 v[238:239], v6 offset:768
    v_mfma_f32_16x16x32_bf16 v[184:187], v[112:115], v[60:63], v[184:187]
    ds_read_b128 v[240:243], v2 offset:7680
    v_mfma_f32_16x16x32_bf16 v[184:187], v[124:127], v[64:67], v[184:187]
    v_mfma_f32_16x16x32_bf16 v[196:199], v[124:127], v[68:71], v[196:199]
    v_mfma_f32_16x16x32_bf16 v[196:199], v[112:115], v[64:67], v[196:199]
    v_mfma_f32_16x16x32_bf16 v[196:199], v[100:103], v[60:63], v[196:199]
    v_mfma_f32_16x16x32_bf16 v[196:199], v[88:91], v[56:59], v[196:199]
    v_mfma_f32_16x16x32_bf16 v[196:199], v[76:79], v[52:55], v[196:199]
    ds_read_b64_tr_b16 v[52:53], v6 offset:18432
    v_mfma_f32_16x16x32_bf16 v[208:211], v[76:79], v[56:59], v[208:211]
    ds_read_b128 v[56:59], v3 offset:3840
    v_mfma_f32_16x16x32_bf16 v[208:211], v[88:91], v[60:63], v[208:211]
    ds_read_b128 v[60:63], v3 offset:1280
    v_mfma_f32_16x16x32_bf16 v[208:211], v[100:103], v[64:67], v[208:211]
    ds_read_b64_tr_b16 v[64:65], v5 offset:55296
    v_mfma_f32_16x16x32_bf16 v[208:211], v[112:115], v[68:71], v[208:211]
    ds_read_b64_tr_b16 v[68:69], v5 offset:43008
    v_mfma_f32_16x16x32_bf16 v[208:211], v[124:127], v[72:75], v[208:211]
    ds_read_b128 v[72:75], v23 offset:3840
    s_waitcnt lgkmcnt(6)
    v_mfma_f32_16x16x32_bf16 v[208:211], v[40:43], v[36:39], v[208:211]
    ds_read_b128 v[124:127], v22 offset:2560
    v_mfma_f32_16x16x32_bf16 v[208:211], v[32:35], v[84:87], v[208:211]
    ds_read_b64_tr_b16 v[70:71], v5 offset:43776
    v_mfma_f32_16x16x32_bf16 v[208:211], v[96:99], v[108:111], v[208:211]
    ds_read_b64_tr_b16 v[112:113], v5 offset:49152
    v_mfma_f32_16x16x32_bf16 v[208:211], v[120:123], v[132:135], v[208:211]
    ds_read_b64_tr_b16 v[114:115], v5 offset:49920
    v_mfma_f32_16x16x32_bf16 v[208:211], v[44:47], v[220:223], v[208:211]
    ds_read_b128 v[220:223], v22 offset:0
    v_mfma_f32_16x16x32_bf16 v[196:199], v[44:47], v[132:135], v[196:199]
    ds_read_b128 v[132:135], v23 offset:1280
    v_mfma_f32_16x16x32_bf16 v[196:199], v[120:123], v[108:111], v[196:199]
    ds_read_b64_tr_b16 v[66:67], v5 offset:56064
    v_mfma_f32_16x16x32_bf16 v[196:199], v[96:99], v[84:87], v[196:199]
    ds_read_b128 v[100:103], v23 offset:6400
    v_mfma_f32_16x16x32_bf16 v[196:199], v[32:35], v[36:39], v[196:199]
    ds_read_b128 v[88:91], v2 offset:2560
    v_mfma_f32_16x16x32_bf16 v[196:199], v[40:43], v[48:51], v[196:199]
    ds_read_b128 v[76:79], v2 offset:5120
    v_mfma_f32_16x16x32_bf16 v[184:187], v[40:43], v[224:227], v[184:187]
    ds_read_b64_tr_b16 v[54:55], v6 offset:19200
    v_mfma_f32_16x16x32_bf16 v[184:187], v[32:35], v[48:51], v[184:187]
    v_cvt_pk_bf16_f32 v208, v208, v209
    v_mfma_f32_16x16x32_bf16 v[184:187], v[96:99], v[36:39], v[184:187]
    v_cvt_pk_bf16_f32 v209, v210, v211
    v_mfma_f32_16x16x32_bf16 v[184:187], v[120:123], v[84:87], v[184:187]
    v_mov_b32 v27, 16
    v_mfma_f32_16x16x32_bf16 v[184:187], v[44:47], v[108:111], v[184:187]
    ds_read_b64_tr_b16 v[108:109], v5 offset:36864
    v_mfma_f32_16x16x32_bf16 v[172:175], v[44:47], v[84:87], v[172:175]
    ds_read_b64_tr_b16 v[84:85], v5 offset:30720
    v_mfma_f32_16x16x32_bf16 v[172:175], v[120:123], v[36:39], v[172:175]
    ds_read_b64_tr_b16 v[86:87], v5 offset:31488
    v_mfma_f32_16x16x32_bf16 v[172:175], v[96:99], v[48:51], v[172:175]
    ds_read_b64_tr_b16 v[110:111], v5 offset:37632
    v_mfma_f32_16x16x32_bf16 v[172:175], v[32:35], v[224:227], v[172:175]
    ds_write_b64 v10, v[208:209] offset:19968
    s_waitcnt lgkmcnt(5)
    v_mfma_f32_16x16x32_bf16 v[172:175], v[40:43], v[72:75], v[172:175]
    ds_write_b32 v25, v27
    v_mfma_f32_16x16x32_bf16 v[160:163], v[40:43], v[124:127], v[160:163]
    v_cvt_pk_bf16_f32 v196, v196, v197
    v_mfma_f32_16x16x32_bf16 v[160:163], v[32:35], v[72:75], v[160:163]
    v_cvt_pk_bf16_f32 v197, v198, v199
    v_mfma_f32_16x16x32_bf16 v[160:163], v[96:99], v[224:227], v[160:163]
    v_mov_b32 v27, 17
    v_mfma_f32_16x16x32_bf16 v[160:163], v[120:123], v[48:51], v[160:163]
    ds_write_b64 v10, v[196:197] offset:16640
    v_mfma_f32_16x16x32_bf16 v[160:163], v[44:47], v[36:39], v[160:163]
    ds_read_b128 v[36:39], v3 offset:6400
    v_mfma_f32_16x16x32_bf16 v[148:151], v[44:47], v[48:51], v[148:151]
    ds_read_b64_tr_b16 v[48:49], v6 offset:24576
    v_mfma_f32_16x16x32_bf16 v[148:151], v[120:123], v[224:227], v[148:151]
    ds_read_b64_tr_b16 v[50:51], v6 offset:25344
    v_mfma_f32_16x16x32_bf16 v[148:151], v[96:99], v[72:75], v[148:151]
    ds_write_b32 v25, v27
    v_mfma_f32_16x16x32_bf16 v[148:151], v[32:35], v[124:127], v[148:151]
    v_cvt_pk_bf16_f32 v184, v184, v185
    v_mfma_f32_16x16x32_bf16 v[148:151], v[40:43], v[132:135], v[148:151]
    v_cvt_pk_bf16_f32 v185, v186, v187
    v_mfma_f32_16x16x32_bf16 v[136:139], v[40:43], v[220:223], v[136:139]
    ds_read_b64_tr_b16 v[40:41], v6 offset:55296
    v_mfma_f32_16x16x32_bf16 v[136:139], v[32:35], v[132:135], v[136:139]
    ds_read_b64_tr_b16 v[42:43], v6 offset:56064
    v_mfma_f32_16x16x32_bf16 v[136:139], v[96:99], v[124:127], v[136:139]
    ds_read_b64_tr_b16 v[32:33], v6 offset:49152
    v_mfma_f32_16x16x32_bf16 v[136:139], v[120:123], v[72:75], v[136:139]
    ds_read_b64_tr_b16 v[34:35], v6 offset:49920
    v_mfma_f32_16x16x32_bf16 v[136:139], v[44:47], v[224:227], v[136:139]
    ds_read_b64_tr_b16 v[96:97], v6 offset:43008
    s_waitcnt lgkmcnt(6)
    v_mfma_f32_16x16x32_bf16 v[152:155], v[84:87], v[132:135], v[152:155]
    ds_read_b64_tr_b16 v[98:99], v6 offset:43776
    v_mfma_f32_16x16x32_bf16 v[152:155], v[108:111], v[124:127], v[152:155]
    ds_read_b64_tr_b16 v[120:121], v6 offset:36864
    v_mfma_f32_16x16x32_bf16 v[152:155], v[68:71], v[72:75], v[152:155]
    ds_read_b64_tr_b16 v[122:123], v6 offset:37632
    v_mfma_f32_16x16x32_bf16 v[152:155], v[112:115], v[224:227], v[152:155]
    ds_read_b64_tr_b16 v[44:45], v6 offset:30720
    v_mfma_f32_16x16x32_bf16 v[152:155], v[64:67], v[100:103], v[152:155]
    ds_read_b64_tr_b16 v[46:47], v6 offset:31488
    v_mfma_f32_16x16x32_bf16 v[152:155], v[80:83], v[60:63], v[152:155]
    ds_read_b128 v[220:223], v22 offset:7680
    v_mfma_f32_16x16x32_bf16 v[152:155], v[92:95], v[88:91], v[152:155]
    v_mov_b32 v27, 18
    v_mfma_f32_16x16x32_bf16 v[152:155], v[104:107], v[56:59], v[152:155]
    ds_write_b64 v10, v[184:185] offset:13312
    v_mfma_f32_16x16x32_bf16 v[152:155], v[116:119], v[76:79], v[152:155]
    ds_write_b32 v25, v27
    v_mfma_f32_16x16x32_bf16 v[152:155], v[128:131], v[36:39], v[152:155]
    v_cvt_pk_bf16_f32 v172, v172, v173
    v_mfma_f32_16x16x32_bf16 v[156:159], v[48:51], v[36:39], v[156:159]
    v_cvt_pk_bf16_f32 v173, v174, v175
    v_mfma_f32_16x16x32_bf16 v[156:159], v[52:55], v[76:79], v[156:159]
    v_mov_b32 v27, 19
    v_mfma_f32_16x16x32_bf16 v[156:159], v[228:231], v[56:59], v[156:159]
    ds_write_b64 v10, v[172:173] offset:9984
    v_mfma_f32_16x16x32_bf16 v[156:159], v[232:235], v[88:91], v[156:159]
    ds_write_b32 v25, v27
    v_mfma_f32_16x16x32_bf16 v[156:159], v[236:239], v[60:63], v[156:159]
    ds_read_b128 v[60:63], v3 offset:8960
    s_waitcnt lgkmcnt(5)
    v_mfma_f32_16x16x32_bf16 v[156:159], v[40:43], v[100:103], v[156:159]
    v_cvt_pk_bf16_f32 v160, v160, v161
    v_mfma_f32_16x16x32_bf16 v[156:159], v[32:35], v[224:227], v[156:159]
    v_cvt_pk_bf16_f32 v161, v162, v163
    v_mfma_f32_16x16x32_bf16 v[156:159], v[96:99], v[72:75], v[156:159]
    v_mov_b32 v27, 20
    v_mfma_f32_16x16x32_bf16 v[156:159], v[120:123], v[124:127], v[156:159]
    ds_write_b64 v10, v[160:161] offset:6656
    v_mfma_f32_16x16x32_bf16 v[156:159], v[44:47], v[132:135], v[156:159]
    ds_read_b128 v[132:135], v23 offset:8960
    v_mfma_f32_16x16x32_bf16 v[168:171], v[44:47], v[124:127], v[168:171]
    ds_write_b32 v25, v27
    v_mfma_f32_16x16x32_bf16 v[168:171], v[120:123], v[72:75], v[168:171]
    v_cvt_pk_bf16_f32 v148, v148, v149
    v_mfma_f32_16x16x32_bf16 v[168:171], v[96:99], v[224:227], v[168:171]
    v_cvt_pk_bf16_f32 v149, v150, v151
    v_mfma_f32_16x16x32_bf16 v[168:171], v[32:35], v[100:103], v[168:171]
    v_mov_b32 v27, 21
    v_mfma_f32_16x16x32_bf16 v[168:171], v[40:43], v[220:223], v[168:171]
    ds_write_b64 v10, v[148:149] offset:3328
    v_mfma_f32_16x16x32_bf16 v[168:171], v[236:239], v[88:91], v[168:171]
    ds_write_b32 v25, v27
    v_mfma_f32_16x16x32_bf16 v[168:171], v[232:235], v[56:59], v[168:171]
    v_cvt_pk_bf16_f32 v136, v136, v137
    v_mfma_f32_16x16x32_bf16 v[168:171], v[228:231], v[76:79], v[168:171]
    v_cvt_pk_bf16_f32 v137, v138, v139
    v_mfma_f32_16x16x32_bf16 v[168:171], v[52:55], v[36:39], v[168:171]
    v_mov_b32 v27, 22
    v_mfma_f32_16x16x32_bf16 v[168:171], v[48:51], v[240:243], v[168:171]
    ds_write_b64 v10, v[136:137] offset:0
    v_mfma_f32_16x16x32_bf16 v[164:167], v[128:131], v[240:243], v[164:167]
    ds_write_b32 v25, v27
    v_mfma_f32_16x16x32_bf16 v[164:167], v[116:119], v[36:39], v[164:167]
    v_cvt_pk_bf16_f32 v152, v152, v153
    v_mfma_f32_16x16x32_bf16 v[164:167], v[104:107], v[76:79], v[164:167]
    v_cvt_pk_bf16_f32 v153, v154, v155
    v_mfma_f32_16x16x32_bf16 v[164:167], v[92:95], v[56:59], v[164:167]
    ds_write_b64 v9, v[152:153] offset:3328
    v_mfma_f32_16x16x32_bf16 v[164:167], v[80:83], v[88:91], v[164:167]
    ds_read_b128 v[88:91], v2 offset:10240
    v_mfma_f32_16x16x32_bf16 v[164:167], v[64:67], v[220:223], v[164:167]
    v_cvt_pk_bf16_f32 v156, v156, v157
    v_mfma_f32_16x16x32_bf16 v[164:167], v[112:115], v[100:103], v[164:167]
    v_cvt_pk_bf16_f32 v157, v158, v159
    v_mfma_f32_16x16x32_bf16 v[164:167], v[68:71], v[224:227], v[164:167]
    v_mov_b32 v27, 25
    v_mfma_f32_16x16x32_bf16 v[164:167], v[108:111], v[72:75], v[164:167]
    ds_write_b64 v9, v[156:157] offset:3360
    v_mfma_f32_16x16x32_bf16 v[164:167], v[84:87], v[124:127], v[164:167]
    ds_read_b128 v[124:127], v22 offset:10240
    v_mfma_f32_16x16x32_bf16 v[176:179], v[84:87], v[72:75], v[176:179]
    ds_write_b32 v25, v27
    v_mfma_f32_16x16x32_bf16 v[176:179], v[108:111], v[224:227], v[176:179]
    v_cvt_pk_bf16_f32 v168, v168, v169
    v_mfma_f32_16x16x32_bf16 v[176:179], v[68:71], v[100:103], v[176:179]
    v_cvt_pk_bf16_f32 v169, v170, v171
    v_mfma_f32_16x16x32_bf16 v[176:179], v[112:115], v[220:223], v[176:179]
    ds_write_b64 v9, v[168:169] offset:6688
    s_waitcnt lgkmcnt(4)
    v_mfma_f32_16x16x32_bf16 v[176:179], v[64:67], v[132:135], v[176:179]
    v_cvt_pk_bf16_f32 v164, v164, v165
    v_mfma_f32_16x16x32_bf16 v[176:179], v[80:83], v[56:59], v[176:179]
    v_cvt_pk_bf16_f32 v165, v166, v167
    v_mfma_f32_16x16x32_bf16 v[176:179], v[92:95], v[76:79], v[176:179]
    v_mov_b32 v27, 26
    v_mfma_f32_16x16x32_bf16 v[176:179], v[104:107], v[36:39], v[176:179]
    ds_write_b64 v9, v[164:165] offset:6656
    v_mfma_f32_16x16x32_bf16 v[176:179], v[116:119], v[240:243], v[176:179]
    ds_write_b32 v25, v27
    v_mfma_f32_16x16x32_bf16 v[176:179], v[128:131], v[60:63], v[176:179]
    v_mfma_f32_16x16x32_bf16 v[180:183], v[48:51], v[60:63], v[180:183]
    v_mfma_f32_16x16x32_bf16 v[180:183], v[52:55], v[240:243], v[180:183]
    v_mfma_f32_16x16x32_bf16 v[180:183], v[228:231], v[36:39], v[180:183]
    v_mfma_f32_16x16x32_bf16 v[180:183], v[232:235], v[76:79], v[180:183]
    v_mfma_f32_16x16x32_bf16 v[180:183], v[236:239], v[56:59], v[180:183]
    ds_read_b128 v[56:59], v3 offset:11520
    v_mfma_f32_16x16x32_bf16 v[180:183], v[40:43], v[132:135], v[180:183]
    v_mfma_f32_16x16x32_bf16 v[180:183], v[32:35], v[220:223], v[180:183]
    v_cvt_pk_bf16_f32 v176, v176, v177
    v_mfma_f32_16x16x32_bf16 v[180:183], v[96:99], v[100:103], v[180:183]
    v_cvt_pk_bf16_f32 v177, v178, v179
    v_mfma_f32_16x16x32_bf16 v[180:183], v[120:123], v[224:227], v[180:183]
    ds_write_b64 v9, v[176:177] offset:9984
    v_mfma_f32_16x16x32_bf16 v[180:183], v[44:47], v[72:75], v[180:183]
    ds_read_b128 v[72:75], v23 offset:11520
    v_mfma_f32_16x16x32_bf16 v[192:195], v[44:47], v[224:227], v[192:195]
    v_mfma_f32_16x16x32_bf16 v[192:195], v[120:123], v[100:103], v[192:195]
    v_mfma_f32_16x16x32_bf16 v[192:195], v[96:99], v[220:223], v[192:195]
    v_mfma_f32_16x16x32_bf16 v[192:195], v[32:35], v[132:135], v[192:195]
    s_waitcnt lgkmcnt(2)
    v_mfma_f32_16x16x32_bf16 v[192:195], v[40:43], v[124:127], v[192:195]
    v_mfma_f32_16x16x32_bf16 v[192:195], v[236:239], v[76:79], v[192:195]
    v_cvt_pk_bf16_f32 v180, v180, v181
    v_mfma_f32_16x16x32_bf16 v[192:195], v[232:235], v[36:39], v[192:195]
    v_cvt_pk_bf16_f32 v181, v182, v183
    v_mfma_f32_16x16x32_bf16 v[192:195], v[228:231], v[240:243], v[192:195]
    v_mov_b32 v27, 27
    v_mfma_f32_16x16x32_bf16 v[192:195], v[52:55], v[60:63], v[192:195]
    ds_write_b64 v9, v[180:181] offset:10016
    v_mfma_f32_16x16x32_bf16 v[192:195], v[48:51], v[88:91], v[192:195]
    ds_write_b32 v25, v27
    v_mfma_f32_16x16x32_bf16 v[188:191], v[128:131], v[88:91], v[188:191]
    v_mfma_f32_16x16x32_bf16 v[188:191], v[116:119], v[60:63], v[188:191]
    v_mfma_f32_16x16x32_bf16 v[188:191], v[104:107], v[240:243], v[188:191]
    v_mfma_f32_16x16x32_bf16 v[188:191], v[92:95], v[36:39], v[188:191]
    v_mfma_f32_16x16x32_bf16 v[188:191], v[80:83], v[76:79], v[188:191]
    ds_read_b128 v[76:79], v2 offset:12800
    v_mfma_f32_16x16x32_bf16 v[188:191], v[64:67], v[124:127], v[188:191]
    v_cvt_pk_bf16_f32 v192, v192, v193
    v_mfma_f32_16x16x32_bf16 v[188:191], v[112:115], v[132:135], v[188:191]
    v_cvt_pk_bf16_f32 v193, v194, v195
    v_mfma_f32_16x16x32_bf16 v[188:191], v[68:71], v[220:223], v[188:191]
    ds_write_b64 v9, v[192:193] offset:13344
    v_mfma_f32_16x16x32_bf16 v[188:191], v[108:111], v[100:103], v[188:191]
    v_mfma_f32_16x16x32_bf16 v[188:191], v[84:87], v[224:227], v[188:191]
    ds_read_b128 v[224:227], v22 offset:12800
    v_mfma_f32_16x16x32_bf16 v[200:203], v[84:87], v[100:103], v[200:203]
    v_mfma_f32_16x16x32_bf16 v[200:203], v[108:111], v[220:223], v[200:203]
    v_mfma_f32_16x16x32_bf16 v[200:203], v[68:71], v[132:135], v[200:203]
    v_mfma_f32_16x16x32_bf16 v[200:203], v[112:115], v[124:127], v[200:203]
    s_waitcnt lgkmcnt(2)
    v_mfma_f32_16x16x32_bf16 v[200:203], v[64:67], v[72:75], v[200:203]
    v_mfma_f32_16x16x32_bf16 v[200:203], v[80:83], v[36:39], v[200:203]
    v_cvt_pk_bf16_f32 v188, v188, v189
    v_mfma_f32_16x16x32_bf16 v[200:203], v[92:95], v[240:243], v[200:203]
    v_cvt_pk_bf16_f32 v189, v190, v191
    v_mfma_f32_16x16x32_bf16 v[200:203], v[104:107], v[60:63], v[200:203]
    v_mov_b32 v27, 28
    v_mfma_f32_16x16x32_bf16 v[200:203], v[116:119], v[88:91], v[200:203]
    ds_write_b64 v9, v[188:189] offset:13312
    v_mfma_f32_16x16x32_bf16 v[200:203], v[128:131], v[56:59], v[200:203]
    ds_write_b32 v25, v27
    v_mfma_f32_16x16x32_bf16 v[204:207], v[48:51], v[56:59], v[204:207]
    v_mfma_f32_16x16x32_bf16 v[204:207], v[52:55], v[88:91], v[204:207]
    v_mfma_f32_16x16x32_bf16 v[204:207], v[228:231], v[60:63], v[204:207]
    v_mfma_f32_16x16x32_bf16 v[204:207], v[232:235], v[240:243], v[204:207]
    v_mfma_f32_16x16x32_bf16 v[204:207], v[236:239], v[36:39], v[204:207]
    v_mfma_f32_16x16x32_bf16 v[204:207], v[40:43], v[72:75], v[204:207]
    v_mfma_f32_16x16x32_bf16 v[204:207], v[32:35], v[124:127], v[204:207]
    v_cvt_pk_bf16_f32 v200, v200, v201
    v_cvt_pk_bf16_f32 v201, v202, v203
    v_mfma_f32_16x16x32_bf16 v[204:207], v[96:99], v[132:135], v[204:207]
    ds_write_b64 v9, v[200:201] offset:16640
    v_mfma_f32_16x16x32_bf16 v[204:207], v[120:123], v[220:223], v[204:207]
    v_mfma_f32_16x16x32_bf16 v[204:207], v[44:47], v[100:103], v[204:207]
    v_mfma_f32_16x16x32_bf16 v[212:215], v[84:87], v[220:223], v[212:215]
    v_mfma_f32_16x16x32_bf16 v[212:215], v[108:111], v[132:135], v[212:215]
    v_mfma_f32_16x16x32_bf16 v[212:215], v[68:71], v[124:127], v[212:215]
    v_mfma_f32_16x16x32_bf16 v[212:215], v[112:115], v[72:75], v[212:215]
    s_waitcnt lgkmcnt(1)
    v_mfma_f32_16x16x32_bf16 v[212:215], v[64:67], v[224:227], v[212:215]
    v_mfma_f32_16x16x32_bf16 v[212:215], v[80:83], v[240:243], v[212:215]
    v_mfma_f32_16x16x32_bf16 v[212:215], v[92:95], v[60:63], v[212:215]
    v_cvt_pk_bf16_f32 v204, v204, v205
    v_cvt_pk_bf16_f32 v205, v206, v207
    v_mfma_f32_16x16x32_bf16 v[212:215], v[104:107], v[88:91], v[212:215]
    v_mov_b32 v27, 29
    ds_write_b64 v9, v[204:205] offset:16672
    v_mfma_f32_16x16x32_bf16 v[212:215], v[116:119], v[56:59], v[212:215]
    ds_write_b32 v25, v27
    v_mfma_f32_16x16x32_bf16 v[212:215], v[128:131], v[76:79], v[212:215]
    v_mfma_f32_16x16x32_bf16 v[216:219], v[48:51], v[76:79], v[216:219]
    v_mfma_f32_16x16x32_bf16 v[216:219], v[52:55], v[56:59], v[216:219]
    v_mfma_f32_16x16x32_bf16 v[216:219], v[228:231], v[88:91], v[216:219]
    v_mfma_f32_16x16x32_bf16 v[216:219], v[232:235], v[60:63], v[216:219]
    v_mfma_f32_16x16x32_bf16 v[216:219], v[236:239], v[240:243], v[216:219]
    v_mfma_f32_16x16x32_bf16 v[216:219], v[40:43], v[224:227], v[216:219]
    v_mfma_f32_16x16x32_bf16 v[216:219], v[32:35], v[72:75], v[216:219]
    v_mfma_f32_16x16x32_bf16 v[216:219], v[96:99], v[124:127], v[216:219]
    v_cvt_pk_bf16_f32 v212, v212, v213
    v_cvt_pk_bf16_f32 v213, v214, v215
    v_mfma_f32_16x16x32_bf16 v[216:219], v[120:123], v[132:135], v[216:219]
    s_add_u32 s48, s47, 516096
    v_mfma_f32_16x16x32_bf16 v[216:219], v[44:47], v[220:223], v[216:219]
    s_nop 7
    v_cvt_pk_bf16_f32 v214, v216, v217
    v_cvt_pk_bf16_f32 v215, v218, v219
    s_nop 1
    v_permlane16_swap_b32 v212, v214
    v_permlane16_swap_b32 v213, v215
    buffer_store_dwordx4 v[212:215], v7, s[24:27], s48 offen sc0 sc1 nt
    s_endpgm
    .p2align 12
L_padf3:
    s_branch L_store2
    s_nop 0
L_fin3:
    ds_read_b64_tr_b16 v[76:77], v4 offset:0
    v_mfma_f32_16x16x32_bf16 v[144:147], v[132:135], v[48:51], v[144:147]
    ds_read_b64_tr_b16 v[78:79], v4 offset:768
    v_mfma_f32_16x16x32_bf16 v[144:147], v[120:123], v[44:47], v[144:147]
    ds_read_b64_tr_b16 v[88:89], v4 offset:6144
    v_mfma_f32_16x16x32_bf16 v[144:147], v[108:111], v[40:43], v[144:147]
    ds_read_b64_tr_b16 v[90:91], v4 offset:6912
    v_mfma_f32_16x16x32_bf16 v[144:147], v[96:99], v[36:39], v[144:147]
    ds_read_b64_tr_b16 v[100:101], v4 offset:12288
    v_mfma_f32_16x16x32_bf16 v[144:147], v[84:87], v[32:35], v[144:147]
    ds_read_b128 v[32:35], v2 offset:0
    v_mfma_f32_16x16x32_bf16 v[156:159], v[84:87], v[36:39], v[156:159]
    ds_read_b128 v[36:39], v3 offset:1280
    v_mfma_f32_16x16x32_bf16 v[156:159], v[96:99], v[40:43], v[156:159]
    ds_read_b64_tr_b16 v[102:103], v4 offset:13056
    v_mfma_f32_16x16x32_bf16 v[156:159], v[108:111], v[44:47], v[156:159]
    ds_read_b64_tr_b16 v[112:113], v4 offset:18432
    v_mfma_f32_16x16x32_bf16 v[156:159], v[120:123], v[48:51], v[156:159]
    ds_read_b64_tr_b16 v[114:115], v4 offset:19200
    v_mfma_f32_16x16x32_bf16 v[156:159], v[132:135], v[52:55], v[156:159]
    ds_read_b64_tr_b16 v[124:125], v4 offset:24576
    v_mfma_f32_16x16x32_bf16 v[168:171], v[132:135], v[56:59], v[168:171]
    ds_read_b64_tr_b16 v[126:127], v4 offset:25344
    v_mfma_f32_16x16x32_bf16 v[168:171], v[120:123], v[52:55], v[168:171]
    ds_read_b64_tr_b16 v[80:81], v5 offset:0
    v_mfma_f32_16x16x32_bf16 v[168:171], v[108:111], v[48:51], v[168:171]
    ds_read_b64_tr_b16 v[82:83], v5 offset:768
    v_mfma_f32_16x16x32_bf16 v[168:171], v[96:99], v[44:47], v[168:171]
    ds_read_b64_tr_b16 v[92:93], v5 offset:6144
    v_mfma_f32_16x16x32_bf16 v[168:171], v[84:87], v[40:43], v[168:171]
    ds_read_b128 v[40:43], v2 offset:2560
    v_mfma_f32_16x16x32_bf16 v[180:183], v[84:87], v[44:47], v[180:183]
    ds_read_b128 v[44:47], v3 offset:3840
    v_mfma_f32_16x16x32_bf16 v[180:183], v[96:99], v[48:51], v[180:183]
    ds_read_b64_tr_b16 v[94:95], v5 offset:6912
    v_mfma_f32_16x16x32_bf16 v[180:183], v[108:111], v[52:55], v[180:183]
    ds_read_b64_tr_b16 v[104:105], v5 offset:12288
    v_mfma_f32_16x16x32_bf16 v[180:183], v[120:123], v[56:59], v[180:183]
    ds_read_b64_tr_b16 v[106:107], v5 offset:13056
    v_mfma_f32_16x16x32_bf16 v[180:183], v[132:135], v[60:63], v[180:183]
    ds_read_b64_tr_b16 v[116:117], v5 offset:18432
    v_mfma_f32_16x16x32_bf16 v[192:195], v[132:135], v[64:67], v[192:195]
    ds_read_b64_tr_b16 v[118:119], v5 offset:19200
    v_mfma_f32_16x16x32_bf16 v[192:195], v[120:123], v[60:63], v[192:195]
    ds_read_b64_tr_b16 v[128:129], v5 offset:24576
    s_add_u32 s46, s46, 1
    v_mfma_f32_16x16x32_bf16 v[192:195], v[108:111], v[56:59], v[192:195]
    ds_read_b64_tr_b16 v[130:131], v5 offset:25344
    v_mfma_f32_16x16x32_bf16 v[192:195], v[96:99], v[52:55], v[192:195]
    v_mfma_f32_16x16x32_bf16 v[192:195], v[84:87], v[48:51], v[192:195]
    ds_read_b128 v[48:51], v2 offset:5120
    v_mfma_f32_16x16x32_bf16 v[204:207], v[84:87], v[52:55], v[204:207]
    ds_read_b128 v[52:55], v3 offset:6400
    v_mfma_f32_16x16x32_bf16 v[204:207], v[96:99], v[56:59], v[204:207]
    ds_read_b128 v[56:59], v2 offset:7680
    v_mfma_f32_16x16x32_bf16 v[204:207], v[108:111], v[60:63], v[204:207]
    ds_read_b128 v[60:63], v3 offset:8960
    v_mfma_f32_16x16x32_bf16 v[204:207], v[120:123], v[64:67], v[204:207]
    ds_read_b128 v[64:67], v2 offset:10240
    v_mfma_f32_16x16x32_bf16 v[204:207], v[132:135], v[68:71], v[204:207]
    ds_read_b128 v[68:71], v3 offset:11520
    s_waitcnt vmcnt(0)
    s_waitcnt lgkmcnt(7)
    v_mfma_f32_16x16x32_bf16 v[136:139], v[76:79], v[32:35], v[136:139]
    ds_read_b64_tr_b16 v[32:33], v4 offset:36864
    v_add_u32 v1, 64, v1
    v_mfma_f32_16x16x32_bf16 v[136:139], v[88:91], v[36:39], v[136:139]
    ds_read_b64_tr_b16 v[34:35], v4 offset:37632
    v_lshrrev_b32 v11, 3, v1
    v_mfma_f32_16x16x32_bf16 v[136:139], v[100:103], v[40:43], v[136:139]
    ds_read_b64_tr_b16 v[84:85], v4 offset:43008
    v_and_b32 v11, 32, v11
    v_mfma_f32_16x16x32_bf16 v[136:139], v[112:115], v[44:47], v[136:139]
    ds_read_b64_tr_b16 v[86:87], v4 offset:43776
    v_xor_b32 v22, v1, v11
    s_waitcnt lgkmcnt(8)
    v_mfma_f32_16x16x32_bf16 v[136:139], v[124:127], v[48:51], v[136:139]
    ds_read_b64_tr_b16 v[108:109], v4 offset:49152
    v_xor_b32 v23, 32, v22
    v_mfma_f32_16x16x32_bf16 v[148:151], v[124:127], v[52:55], v[148:151]
    ds_read_b64_tr_b16 v[110:111], v4 offset:49920
    v_mfma_f32_16x16x32_bf16 v[148:151], v[112:115], v[48:51], v[148:151]
    ds_read_b128 v[72:75], v22 offset:7680
    v_mfma_f32_16x16x32_bf16 v[148:151], v[100:103], v[44:47], v[148:151]
    ds_read_b128 v[96:99], v23 offset:8960
    v_mfma_f32_16x16x32_bf16 v[148:151], v[88:91], v[40:43], v[148:151]
    ds_read_b128 v[120:123], v22 offset:10240
    v_mfma_f32_16x16x32_bf16 v[148:151], v[76:79], v[36:39], v[148:151]
    ds_read_b128 v[36:39], v23 offset:6400
    v_mfma_f32_16x16x32_bf16 v[160:163], v[76:79], v[40:43], v[160:163]
    ds_read_b64_tr_b16 v[40:41], v4 offset:30720
    v_mfma_f32_16x16x32_bf16 v[160:163], v[88:91], v[44:47], v[160:163]
    ds_read_b64_tr_b16 v[42:43], v4 offset:31488
    v_mfma_f32_16x16x32_bf16 v[160:163], v[100:103], v[48:51], v[160:163]
    ds_read_b64_tr_b16 v[132:133], v4 offset:55296
    v_mfma_f32_16x16x32_bf16 v[160:163], v[112:115], v[52:55], v[160:163]
    ds_read_b64_tr_b16 v[134:135], v4 offset:56064
    s_waitcnt lgkmcnt(8)
    v_mfma_f32_16x16x32_bf16 v[160:163], v[124:127], v[56:59], v[160:163]
    ds_read_b128 v[220:223], v23 offset:11520
    v_mfma_f32_16x16x32_bf16 v[172:175], v[124:127], v[60:63], v[172:175]
    ds_read_b64_tr_b16 v[224:225], v6 offset:18432
    v_mfma_f32_16x16x32_bf16 v[172:175], v[112:115], v[56:59], v[172:175]
    ds_read_b64_tr_b16 v[226:227], v6 offset:19200
    v_mfma_f32_16x16x32_bf16 v[172:175], v[100:103], v[52:55], v[172:175]
    ds_read_b64_tr_b16 v[228:229], v6 offset:12288
    v_mfma_f32_16x16x32_bf16 v[172:175], v[88:91], v[48:51], v[172:175]
    ds_read_b64_tr_b16 v[230:231], v6 offset:13056
    v_mfma_f32_16x16x32_bf16 v[172:175], v[76:79], v[44:47], v[172:175]
    ds_read_b128 v[44:47], v22 offset:5120
    v_mfma_f32_16x16x32_bf16 v[184:187], v[76:79], v[48:51], v[184:187]
    ds_read_b128 v[48:51], v23 offset:3840
    v_mfma_f32_16x16x32_bf16 v[184:187], v[88:91], v[52:55], v[184:187]
    ds_read_b64_tr_b16 v[232:233], v6 offset:6144
    v_mfma_f32_16x16x32_bf16 v[184:187], v[100:103], v[56:59], v[184:187]
    ds_read_b64_tr_b16 v[234:235], v6 offset:6912
    v_mfma_f32_16x16x32_bf16 v[184:187], v[112:115], v[60:63], v[184:187]
    ds_read_b128 v[236:239], v23 offset:6400
    v_mfma_f32_16x16x32_bf16 v[184:187], v[124:127], v[64:67], v[184:187]
    ds_read_b128 v[240:243], v3 offset:6400
    v_mfma_f32_16x16x32_bf16 v[196:199], v[124:127], v[68:71], v[196:199]
    ds_read_b128 v[68:71], v2 offset:5120
    v_mfma_f32_16x16x32_bf16 v[196:199], v[112:115], v[64:67], v[196:199]
    ds_read_b128 v[64:67], v2 offset:2560
    v_mfma_f32_16x16x32_bf16 v[196:199], v[100:103], v[60:63], v[196:199]
    ds_read_b64_tr_b16 v[60:61], v5 offset:49152
    v_mfma_f32_16x16x32_bf16 v[196:199], v[88:91], v[56:59], v[196:199]
    ds_read_b64_tr_b16 v[56:57], v5 offset:36864
    v_mfma_f32_16x16x32_bf16 v[196:199], v[76:79], v[52:55], v[196:199]
    ds_read_b128 v[52:55], v22 offset:2560
    s_waitcnt lgkmcnt(8)
    v_mfma_f32_16x16x32_bf16 v[196:199], v[40:43], v[36:39], v[196:199]
    ds_read_b128 v[76:79], v23 offset:1280
    v_mfma_f32_16x16x32_bf16 v[196:199], v[32:35], v[72:75], v[196:199]
    ds_read_b64_tr_b16 v[58:59], v5 offset:37632
    v_mfma_f32_16x16x32_bf16 v[196:199], v[84:87], v[96:99], v[196:199]
    ds_read_b64_tr_b16 v[88:89], v5 offset:43008
    v_mfma_f32_16x16x32_bf16 v[196:199], v[108:111], v[120:123], v[196:199]
    ds_read_b64_tr_b16 v[90:91], v5 offset:43776
    v_mfma_f32_16x16x32_bf16 v[196:199], v[132:135], v[220:223], v[196:199]
    ds_read_b64_tr_b16 v[220:221], v5 offset:30720
    v_mfma_f32_16x16x32_bf16 v[184:187], v[132:135], v[120:123], v[184:187]
    ds_read_b128 v[120:123], v22 offset:0
    v_mfma_f32_16x16x32_bf16 v[184:187], v[108:111], v[96:99], v[184:187]
    ds_read_b64_tr_b16 v[222:223], v5 offset:31488
    v_mfma_f32_16x16x32_bf16 v[184:187], v[84:87], v[72:75], v[184:187]
    ds_read_b64_tr_b16 v[62:63], v5 offset:49920
    v_mfma_f32_16x16x32_bf16 v[184:187], v[32:35], v[36:39], v[184:187]
    ds_read_b128 v[100:103], v3 offset:1280
    v_mfma_f32_16x16x32_bf16 v[184:187], v[40:43], v[44:47], v[184:187]
    ds_read_b128 v[112:115], v3 offset:3840
    v_mfma_f32_16x16x32_bf16 v[172:175], v[40:43], v[48:51], v[172:175]
    ds_read_b64_tr_b16 v[124:125], v6 offset:24576
    v_mfma_f32_16x16x32_bf16 v[172:175], v[32:35], v[44:47], v[172:175]
    ds_read_b64_tr_b16 v[126:127], v6 offset:25344
    v_mfma_f32_16x16x32_bf16 v[172:175], v[84:87], v[36:39], v[172:175]
    v_cvt_pk_bf16_f32 v196, v196, v197
    v_mfma_f32_16x16x32_bf16 v[172:175], v[108:111], v[72:75], v[172:175]
    v_cvt_pk_bf16_f32 v197, v198, v199
    v_mfma_f32_16x16x32_bf16 v[172:175], v[132:135], v[96:99], v[172:175]
    ds_read_b64_tr_b16 v[96:97], v5 offset:55296
    v_mfma_f32_16x16x32_bf16 v[160:163], v[132:135], v[72:75], v[160:163]
    ds_read_b64_tr_b16 v[98:99], v5 offset:56064
    v_mfma_f32_16x16x32_bf16 v[160:163], v[108:111], v[36:39], v[160:163]
    ds_read_b128 v[72:75], v2 offset:0
    v_mfma_f32_16x16x32_bf16 v[160:163], v[84:87], v[44:47], v[160:163]
    v_mov_b32 v27, 16
    v_mfma_f32_16x16x32_bf16 v[160:163], v[32:35], v[48:51], v[160:163]
    ds_write_b64 v10, v[196:197] offset:16640
    s_waitcnt lgkmcnt(5)
    v_mfma_f32_16x16x32_bf16 v[160:163], v[40:43], v[52:55], v[160:163]
    ds_write_b32 v25, v27
    v_mfma_f32_16x16x32_bf16 v[148:151], v[40:43], v[76:79], v[148:151]
    v_cvt_pk_bf16_f32 v184, v184, v185
    v_mfma_f32_16x16x32_bf16 v[148:151], v[32:35], v[52:55], v[148:151]
    v_cvt_pk_bf16_f32 v185, v186, v187
    v_mfma_f32_16x16x32_bf16 v[148:151], v[84:87], v[48:51], v[148:151]
    v_mov_b32 v27, 17
    v_mfma_f32_16x16x32_bf16 v[148:151], v[108:111], v[44:47], v[148:151]
    ds_write_b64 v10, v[184:185] offset:13312
    v_mfma_f32_16x16x32_bf16 v[148:151], v[132:135], v[36:39], v[148:151]
    ds_read_b64_tr_b16 v[36:37], v6 offset:0
    v_mfma_f32_16x16x32_bf16 v[136:139], v[132:135], v[44:47], v[136:139]
    ds_read_b64_tr_b16 v[38:39], v6 offset:768
    v_mfma_f32_16x16x32_bf16 v[136:139], v[108:111], v[48:51], v[136:139]
    ds_read_b64_tr_b16 v[132:133], v6 offset:55296
    v_mfma_f32_16x16x32_bf16 v[136:139], v[84:87], v[52:55], v[136:139]
    ds_read_b64_tr_b16 v[134:135], v6 offset:56064
    v_mfma_f32_16x16x32_bf16 v[136:139], v[32:35], v[76:79], v[136:139]
    ds_read_b64_tr_b16 v[108:109], v6 offset:49152
    v_mfma_f32_16x16x32_bf16 v[136:139], v[40:43], v[120:123], v[136:139]
    ds_read_b64_tr_b16 v[110:111], v6 offset:49920
    v_mfma_f32_16x16x32_bf16 v[140:143], v[220:223], v[120:123], v[140:143]
    ds_read_b64_tr_b16 v[84:85], v6 offset:43008
    v_mfma_f32_16x16x32_bf16 v[140:143], v[56:59], v[76:79], v[140:143]
    ds_read_b64_tr_b16 v[86:87], v6 offset:43776
    v_mfma_f32_16x16x32_bf16 v[140:143], v[88:91], v[52:55], v[140:143]
    ds_read_b64_tr_b16 v[32:33], v6 offset:36864
    v_mfma_f32_16x16x32_bf16 v[140:143], v[60:63], v[48:51], v[140:143]
    ds_read_b64_tr_b16 v[34:35], v6 offset:37632
    s_waitcnt lgkmcnt(8)
    v_mfma_f32_16x16x32_bf16 v[140:143], v[96:99], v[44:47], v[140:143]
    ds_read_b64_tr_b16 v[40:41], v6 offset:30720
    v_mfma_f32_16x16x32_bf16 v[140:143], v[80:83], v[72:75], v[140:143]
    ds_read_b64_tr_b16 v[42:43], v6 offset:31488
    v_mfma_f32_16x16x32_bf16 v[140:143], v[92:95], v[100:103], v[140:143]
    ds_write_b32 v25, v27
    v_mfma_f32_16x16x32_bf16 v[140:143], v[104:107], v[64:67], v[140:143]
    v_cvt_pk_bf16_f32 v172, v172, v173
    v_mfma_f32_16x16x32_bf16 v[140:143], v[116:119], v[112:115], v[140:143]
    v_cvt_pk_bf16_f32 v173, v174, v175
    v_mfma_f32_16x16x32_bf16 v[140:143], v[128:131], v[68:71], v[140:143]
    v_mov_b32 v27, 18
    v_mfma_f32_16x16x32_bf16 v[144:147], v[124:127], v[68:71], v[144:147]
    ds_write_b64 v10, v[172:173] offset:9984
    v_mfma_f32_16x16x32_bf16 v[144:147], v[224:227], v[112:115], v[144:147]
    ds_write_b32 v25, v27
    v_mfma_f32_16x16x32_bf16 v[144:147], v[228:231], v[64:67], v[144:147]
    v_cvt_pk_bf16_f32 v160, v160, v161
    v_mfma_f32_16x16x32_bf16 v[144:147], v[232:235], v[100:103], v[144:147]
    v_cvt_pk_bf16_f32 v161, v162, v163
    v_mfma_f32_16x16x32_bf16 v[144:147], v[36:39], v[72:75], v[144:147]
    ds_read_b128 v[72:75], v2 offset:7680
    s_waitcnt lgkmcnt(3)
    v_mfma_f32_16x16x32_bf16 v[144:147], v[132:135], v[44:47], v[144:147]
    v_mov_b32 v27, 19
    v_mfma_f32_16x16x32_bf16 v[144:147], v[108:111], v[48:51], v[144:147]
    ds_write_b64 v10, v[160:161] offset:6656
    v_mfma_f32_16x16x32_bf16 v[144:147], v[84:87], v[52:55], v[144:147]
    ds_write_b32 v25, v27
    v_mfma_f32_16x16x32_bf16 v[144:147], v[32:35], v[76:79], v[144:147]
    v_cvt_pk_bf16_f32 v148, v148, v149
    v_mfma_f32_16x16x32_bf16 v[144:147], v[40:43], v[120:123], v[144:147]
    ds_read_b128 v[120:123], v22 offset:7680
    v_mfma_f32_16x16x32_bf16 v[156:159], v[40:43], v[76:79], v[156:159]
    v_cvt_pk_bf16_f32 v149, v150, v151
    v_mfma_f32_16x16x32_bf16 v[156:159], v[32:35], v[52:55], v[156:159]
    v_mov_b32 v27, 20
    v_mfma_f32_16x16x32_bf16 v[156:159], v[84:87], v[48:51], v[156:159]
    ds_write_b64 v10, v[148:149] offset:3328
    v_mfma_f32_16x16x32_bf16 v[156:159], v[108:111], v[44:47], v[156:159]
    ds_write_b32 v25, v27
    v_mfma_f32_16x16x32_bf16 v[156:159], v[132:135], v[236:239], v[156:159]
    v_cvt_pk_bf16_f32 v136, v136, v137
    v_mfma_f32_16x16x32_bf16 v[156:159], v[36:39], v[100:103], v[156:159]
    v_cvt_pk_bf16_f32 v137, v138, v139
    v_mfma_f32_16x16x32_bf16 v[156:159], v[232:235], v[64:67], v[156:159]
    v_mov_b32 v27, 21
    v_mfma_f32_16x16x32_bf16 v[156:159], v[228:231], v[112:115], v[156:159]
    ds_write_b64 v10, v[136:137] offset:0
    v_mfma_f32_16x16x32_bf16 v[156:159], v[224:227], v[68:71], v[156:159]
    ds_write_b32 v25, v27
    v_mfma_f32_16x16x32_bf16 v[156:159], v[124:127], v[240:243], v[156:159]
    v_cvt_pk_bf16_f32 v140, v140, v141
    v_mfma_f32_16x16x32_bf16 v[152:155], v[128:131], v[240:243], v[152:155]
    v_cvt_pk_bf16_f32 v141, v142, v143
    v_mfma_f32_16x16x32_bf16 v[152:155], v[116:119], v[68:71], v[152:155]
    ds_write_b64 v9, v[140:141] offset:0
    v_mfma_f32_16x16x32_bf16 v[152:155], v[104:107], v[112:115], v[152:155]
    v_cvt_pk_bf16_f32 v144, v144, v145
    v_mfma_f32_16x16x32_bf16 v[152:155], v[92:95], v[64:67], v[152:155]
    v_cvt_pk_bf16_f32 v145, v146, v147
    v_mfma_f32_16x16x32_bf16 v[152:155], v[80:83], v[100:103], v[152:155]
    ds_read_b128 v[100:103], v3 offset:8960
    v_mfma_f32_16x16x32_bf16 v[152:155], v[96:99], v[236:239], v[152:155]
    v_mov_b32 v27, 25
    v_mfma_f32_16x16x32_bf16 v[152:155], v[60:63], v[44:47], v[152:155]
    ds_write_b64 v9, v[144:145] offset:32
    v_mfma_f32_16x16x32_bf16 v[152:155], v[88:91], v[48:51], v[152:155]
    ds_write_b32 v25, v27
    v_mfma_f32_16x16x32_bf16 v[152:155], v[56:59], v[52:55], v[152:155]
    v_cvt_pk_bf16_f32 v156, v156, v157
    v_mfma_f32_16x16x32_bf16 v[152:155], v[220:223], v[76:79], v[152:155]
    ds_read_b128 v[76:79], v23 offset:8960
    v_mfma_f32_16x16x32_bf16 v[164:167], v[220:223], v[52:55], v[164:167]
    v_cvt_pk_bf16_f32 v157, v158, v159
    v_mfma_f32_16x16x32_bf16 v[164:167], v[56:59], v[48:51], v[164:167]
    ds_write_b64 v9, v[156:157] offset:3360
    v_mfma_f32_16x16x32_bf16 v[164:167], v[88:91], v[44:47], v[164:167]
    v_mfma_f32_16x16x32_bf16 v[164:167], v[60:63], v[236:239], v[164:167]
    s_waitcnt lgkmcnt(4)
    v_mfma_f32_16x16x32_bf16 v[164:167], v[96:99], v[120:123], v[164:167]
    v_cvt_pk_bf16_f32 v152, v152, v153
    v_mfma_f32_16x16x32_bf16 v[164:167], v[80:83], v[64:67], v[164:167]
    v_cvt_pk_bf16_f32 v153, v154, v155
    v_mfma_f32_16x16x32_bf16 v[164:167], v[92:95], v[112:115], v[164:167]
    v_mov_b32 v27, 26
    v_mfma_f32_16x16x32_bf16 v[164:167], v[104:107], v[68:71], v[164:167]
    ds_write_b64 v9, v[152:153] offset:3328
    v_mfma_f32_16x16x32_bf16 v[164:167], v[116:119], v[240:243], v[164:167]
    ds_write_b32 v25, v27
    v_mfma_f32_16x16x32_bf16 v[164:167], v[128:131], v[72:75], v[164:167]
    v_mfma_f32_16x16x32_bf16 v[168:171], v[124:127], v[72:75], v[168:171]
    v_mfma_f32_16x16x32_bf16 v[168:171], v[224:227], v[240:243], v[168:171]
    v_mfma_f32_16x16x32_bf16 v[168:171], v[228:231], v[68:71], v[168:171]
    v_mfma_f32_16x16x32_bf16 v[168:171], v[232:235], v[112:115], v[168:171]
    v_mfma_f32_16x16x32_bf16 v[168:171], v[36:39], v[64:67], v[168:171]
    ds_read_b128 v[64:67], v2 offset:10240
    v_mfma_f32_16x16x32_bf16 v[168:171], v[132:135], v[120:123], v[168:171]
    v_mfma_f32_16x16x32_bf16 v[168:171], v[108:111], v[236:239], v[168:171]
    v_cvt_pk_bf16_f32 v164, v164, v165
    v_mfma_f32_16x16x32_bf16 v[168:171], v[84:87], v[44:47], v[168:171]
    v_cvt_pk_bf16_f32 v165, v166, v167
    v_mfma_f32_16x16x32_bf16 v[168:171], v[32:35], v[48:51], v[168:171]
    ds_write_b64 v9, v[164:165] offset:6656
    v_mfma_f32_16x16x32_bf16 v[168:171], v[40:43], v[52:55], v[168:171]
    ds_read_b128 v[52:55], v22 offset:10240
    v_mfma_f32_16x16x32_bf16 v[180:183], v[40:43], v[48:51], v[180:183]
    v_mfma_f32_16x16x32_bf16 v[180:183], v[32:35], v[44:47], v[180:183]
    v_mfma_f32_16x16x32_bf16 v[180:183], v[84:87], v[236:239], v[180:183]
    v_mfma_f32_16x16x32_bf16 v[180:183], v[108:111], v[120:123], v[180:183]
    s_waitcnt lgkmcnt(2)
    v_mfma_f32_16x16x32_bf16 v[180:183], v[132:135], v[76:79], v[180:183]
    v_mfma_f32_16x16x32_bf16 v[180:183], v[36:39], v[112:115], v[180:183]
    v_cvt_pk_bf16_f32 v168, v168, v169
    v_mfma_f32_16x16x32_bf16 v[180:183], v[232:235], v[68:71], v[180:183]
    v_cvt_pk_bf16_f32 v169, v170, v171
    v_mfma_f32_16x16x32_bf16 v[180:183], v[228:231], v[240:243], v[180:183]
    v_mov_b32 v27, 27
    v_mfma_f32_16x16x32_bf16 v[180:183], v[224:227], v[72:75], v[180:183]
    ds_write_b64 v9, v[168:169] offset:6688
    v_mfma_f32_16x16x32_bf16 v[180:183], v[124:127], v[100:103], v[180:183]
    ds_write_b32 v25, v27
    v_mfma_f32_16x16x32_bf16 v[176:179], v[128:131], v[100:103], v[176:179]
    v_mfma_f32_16x16x32_bf16 v[176:179], v[116:119], v[72:75], v[176:179]
    v_mfma_f32_16x16x32_bf16 v[176:179], v[104:107], v[240:243], v[176:179]
    v_mfma_f32_16x16x32_bf16 v[176:179], v[92:95], v[68:71], v[176:179]
    v_mfma_f32_16x16x32_bf16 v[176:179], v[80:83], v[112:115], v[176:179]
    ds_read_b128 v[112:115], v3 offset:11520
    v_mfma_f32_16x16x32_bf16 v[176:179], v[96:99], v[76:79], v[176:179]
    v_cvt_pk_bf16_f32 v180, v180, v181
    v_mfma_f32_16x16x32_bf16 v[176:179], v[60:63], v[120:123], v[176:179]
    v_cvt_pk_bf16_f32 v181, v182, v183
    v_mfma_f32_16x16x32_bf16 v[176:179], v[88:91], v[236:239], v[176:179]
    ds_write_b64 v9, v[180:181] offset:10016
    v_mfma_f32_16x16x32_bf16 v[176:179], v[56:59], v[44:47], v[176:179]
    v_mfma_f32_16x16x32_bf16 v[176:179], v[220:223], v[48:51], v[176:179]
    ds_read_b128 v[48:51], v23 offset:11520
    v_mfma_f32_16x16x32_bf16 v[188:191], v[220:223], v[44:47], v[188:191]
    v_mfma_f32_16x16x32_bf16 v[188:191], v[56:59], v[236:239], v[188:191]
    v_mfma_f32_16x16x32_bf16 v[188:191], v[88:91], v[120:123], v[188:191]
    v_mfma_f32_16x16x32_bf16 v[188:191], v[60:63], v[76:79], v[188:191]
    s_waitcnt lgkmcnt(2)
    v_mfma_f32_16x16x32_bf16 v[188:191], v[96:99], v[52:55], v[188:191]
    v_mfma_f32_16x16x32_bf16 v[188:191], v[80:83], v[68:71], v[188:191]
    v_cvt_pk_bf16_f32 v176, v176, v177
    v_mfma_f32_16x16x32_bf16 v[188:191], v[92:95], v[240:243], v[188:191]
    v_cvt_pk_bf16_f32 v177, v178, v179
    v_mfma_f32_16x16x32_bf16 v[188:191], v[104:107], v[72:75], v[188:191]
    v_mov_b32 v27, 28
    v_mfma_f32_16x16x32_bf16 v[188:191], v[116:119], v[100:103], v[188:191]
    ds_write_b64 v9, v[176:177] offset:9984
    v_mfma_f32_16x16x32_bf16 v[188:191], v[128:131], v[64:67], v[188:191]
    ds_write_b32 v25, v27
    v_mfma_f32_16x16x32_bf16 v[192:195], v[124:127], v[64:67], v[192:195]
    v_mfma_f32_16x16x32_bf16 v[192:195], v[224:227], v[100:103], v[192:195]
    v_mfma_f32_16x16x32_bf16 v[192:195], v[228:231], v[72:75], v[192:195]
    v_mfma_f32_16x16x32_bf16 v[192:195], v[232:235], v[240:243], v[192:195]
    v_mfma_f32_16x16x32_bf16 v[192:195], v[36:39], v[68:71], v[192:195]
    v_mfma_f32_16x16x32_bf16 v[192:195], v[132:135], v[52:55], v[192:195]
    v_mfma_f32_16x16x32_bf16 v[192:195], v[108:111], v[76:79], v[192:195]
    v_cvt_pk_bf16_f32 v188, v188, v189
    v_cvt_pk_bf16_f32 v189, v190, v191
    v_mfma_f32_16x16x32_bf16 v[192:195], v[84:87], v[120:123], v[192:195]
    ds_write_b64 v9, v[188:189] offset:13312
    v_mfma_f32_16x16x32_bf16 v[192:195], v[32:35], v[236:239], v[192:195]
    v_mfma_f32_16x16x32_bf16 v[192:195], v[40:43], v[44:47], v[192:195]
    v_mfma_f32_16x16x32_bf16 v[200:203], v[220:223], v[236:239], v[200:203]
    v_mfma_f32_16x16x32_bf16 v[200:203], v[56:59], v[120:123], v[200:203]
    v_mfma_f32_16x16x32_bf16 v[200:203], v[88:91], v[76:79], v[200:203]
    v_mfma_f32_16x16x32_bf16 v[200:203], v[60:63], v[52:55], v[200:203]
    s_waitcnt lgkmcnt(1)
    v_mfma_f32_16x16x32_bf16 v[200:203], v[96:99], v[48:51], v[200:203]
    v_mfma_f32_16x16x32_bf16 v[200:203], v[80:83], v[240:243], v[200:203]
    v_mfma_f32_16x16x32_bf16 v[200:203], v[92:95], v[72:75], v[200:203]
    v_cvt_pk_bf16_f32 v192, v192, v193
    v_cvt_pk_bf16_f32 v193, v194, v195
    v_mfma_f32_16x16x32_bf16 v[200:203], v[104:107], v[100:103], v[200:203]
    v_mov_b32 v27, 29
    ds_write_b64 v9, v[192:193] offset:13344
    v_mfma_f32_16x16x32_bf16 v[200:203], v[116:119], v[64:67], v[200:203]
    ds_write_b32 v25, v27
    v_mfma_f32_16x16x32_bf16 v[200:203], v[128:131], v[112:115], v[200:203]
    v_mfma_f32_16x16x32_bf16 v[204:207], v[124:127], v[112:115], v[204:207]
    v_mfma_f32_16x16x32_bf16 v[204:207], v[224:227], v[64:67], v[204:207]
    v_mfma_f32_16x16x32_bf16 v[204:207], v[228:231], v[100:103], v[204:207]
    v_mfma_f32_16x16x32_bf16 v[204:207], v[232:235], v[72:75], v[204:207]
    v_mfma_f32_16x16x32_bf16 v[204:207], v[36:39], v[240:243], v[204:207]
    v_mfma_f32_16x16x32_bf16 v[204:207], v[132:135], v[48:51], v[204:207]
    v_mfma_f32_16x16x32_bf16 v[204:207], v[108:111], v[52:55], v[204:207]
    v_mfma_f32_16x16x32_bf16 v[204:207], v[84:87], v[76:79], v[204:207]
    v_cvt_pk_bf16_f32 v200, v200, v201
    v_cvt_pk_bf16_f32 v201, v202, v203
    v_mfma_f32_16x16x32_bf16 v[204:207], v[32:35], v[120:123], v[204:207]
    s_add_u32 s48, s47, 430080
    v_mfma_f32_16x16x32_bf16 v[204:207], v[40:43], v[236:239], v[204:207]
    s_nop 7
    v_cvt_pk_bf16_f32 v202, v204, v205
    v_cvt_pk_bf16_f32 v203, v206, v207
    s_nop 1
    v_permlane16_swap_b32 v200, v202
    v_permlane16_swap_b32 v201, v203
    buffer_store_dwordx4 v[200:203], v7, s[24:27], s48 offen sc0 sc1 nt
    s_endpgm
L_end:
    s_endpgm
    s_endpgm
    s_endpgm
    s_endpgm
    s_endpgm
    s_endpgm
    s_endpgm
    s_endpgm
    s_endpgm
    s_endpgm
    s_endpgm
    s_endpgm
    s_endpgm
    s_endpgm
    s_endpgm
    s_endpgm
    s_endpgm
    s_endpgm
    s_endpgm
    s_endpgm
    s_endpgm
    s_endpgm
    s_endpgm
    s_endpgm
    s_endpgm
    s_endpgm
    s_endpgm
    s_endpgm
    s_endpgm
    s_endpgm
    s_endpgm
    s_endpgm
    s_endpgm
    s_endpgm
    s_endpgm
    s_endpgm
    s_endpgm
    s_endpgm
    s_endpgm
    s_endpgm
    s_endpgm
    s_endpgm
    s_endpgm
    s_endpgm
    s_endpgm
    s_endpgm
    s_endpgm
    s_endpgm
    s_endpgm
    s_endpgm
    s_endpgm
    s_endpgm
    s_endpgm
    s_endpgm
    s_endpgm
    s_endpgm
    s_endpgm
    s_endpgm
    s_endpgm
    s_endpgm
    s_endpgm
    s_endpgm
    s_endpgm
    s_endpgm
    s_endpgm
    s_endpgm
    s_endpgm
    s_endpgm
    s_endpgm
    s_endpgm
    s_endpgm
    s_endpgm
    s_endpgm
    s_endpgm
    s_endpgm
    s_endpgm
    s_endpgm
    s_endpgm
    s_endpgm
    s_endpgm
    s_endpgm
    s_endpgm
    s_endpgm
    s_endpgm
    s_endpgm
    s_endpgm
    s_endpgm
    s_endpgm
    s_endpgm
    s_endpgm
    s_endpgm
    s_endpgm
    s_endpgm
    s_endpgm
    s_endpgm
    s_endpgm
    s_endpgm
    s_endpgm
    s_endpgm
    s_endpgm
.section .rodata,"a"
.p2align 6
.amdhsa_kernel standalone__dilated_atrous__vision_kernel
  .amdhsa_next_free_vgpr 256
  .amdhsa_next_free_sgpr 96
  .amdhsa_accum_offset 256
  .amdhsa_group_segment_fixed_size 0
  .amdhsa_kernarg_size 40
  .amdhsa_user_sgpr_count 2
  .amdhsa_user_sgpr_kernarg_segment_ptr 1
  .amdhsa_system_sgpr_workgroup_id_x 1
.end_amdhsa_kernel
```
